```python
import torch

def _softmax(x, axis=-1):
    return torch.softmax(x, dim=axis)
def _gelu(x):
    return torch.nn.functional.gelu(x, approximate="tanh")
def _silu(x):
    return torch.nn.functional.silu(x)
def _sigmoid(x):
    return torch.sigmoid(x)
def _layernorm(x, axis=-1, eps=1e-5):
    m = x.mean(dim=axis, keepdim=True)
    v = x.var(dim=axis, keepdim=True, unbiased=False)
    return (x - m) / torch.sqrt(v + eps)
def _scatter_add(tgt, idx, src, axis=0):
    return tgt.clone().index_add_(axis, idx, src)
def _segment_sum(src, seg, n):
    out = torch.zeros((n,) + src.shape[1:], dtype=src.dtype)
    return out.index_add_(0, seg, src)
def _pad(x, pw):
    flat = tuple(v for pair in reversed(pw) for v in pair)
    return torch.nn.functional.pad(x, flat)

kernel_name = 'parallel_sum__ssm_conv_s4d__moe_arch_mod__prompt'

def setup_inputs():

    _w = (lambda a: (lambda t: t.to(torch.bfloat16) if t.is_floating_point() else t)(torch.as_tensor(a)))
    def _A_setup():
        Bsz, L, D, N = 1, 2048, 1024, 128
        return {
            "u": _w((lambda *s: torch.randn(*s, dtype=torch.bfloat16) * 0.05)(Bsz, L, D)),
            "log_A_real": _w((lambda *s: torch.randn(*s, dtype=torch.bfloat16) * 3.2)(D, N) * 0.5),
            "A_imag": _w((lambda *s: torch.randn(*s, dtype=torch.bfloat16) * 0.2)(D, N) * 3.14),
            "C_real": _w((lambda *s: torch.randn(*s, dtype=torch.bfloat16) * 3.2)(D, N) / N ** 0.5),
            "C_imag": _w((lambda *s: torch.randn(*s, dtype=torch.bfloat16) * 3.2)(D, N) / N ** 0.5),
            "log_dt": _w((lambda *s: torch.randn(*s, dtype=torch.bfloat16) * 0.2)(D) * 0.5 - 4.0),
            "D_skip": _w((lambda *s: torch.randn(*s, dtype=torch.bfloat16) * 0.4)(D)),
        }
    _A_in = _A_setup()

    def _B_setup():
        B, S, D, F, C = 1, 2048, 1024, 3584, 1
        return {
            "x": _w((lambda *s: torch.randn(*s, dtype=torch.bfloat16) * 0.05)(B, S, D)),
            "w_r": _w((lambda *s: torch.randn(*s, dtype=torch.bfloat16) * 0.05)(D)),
            "w_gate": _w((lambda *s: torch.randn(*s, dtype=torch.bfloat16) * 0.05)(D, F)),
            "w_up": _w((lambda *s: torch.randn(*s, dtype=torch.bfloat16) * 0.05)(D, F)),
            "w_down": _w((lambda *s: torch.randn(*s, dtype=torch.bfloat16) * 0.05)(F, D)),
        }
    _B_in = _B_setup()

    return {
        "A_u": _A_in["u"],
        "A_log_A_real": _A_in["log_A_real"],
        "A_A_imag": _A_in["A_imag"],
        "A_C_real": _A_in["C_real"],
        "A_C_imag": _A_in["C_imag"],
        "A_log_dt": _A_in["log_dt"],
        "A_D_skip": _A_in["D_skip"],
        "B_x": _B_in["x"],
        "B_w_r": _B_in["w_r"],
        "B_w_gate": _B_in["w_gate"],
        "B_w_up": _B_in["w_up"],
        "B_w_down": _B_in["w_down"],
    }

def reference(A_u, A_log_A_real, A_A_imag, A_C_real, A_C_imag, A_log_dt, A_D_skip, B_x, B_w_r, B_w_gate, B_w_up, B_w_down):
    def _A_ref(u, log_A_real, A_imag, C_real, C_imag, log_dt, D_skip):
        L = u.shape[1]
        dt = torch.exp(log_dt)
        A = -torch.exp(log_A_real) + 1j * A_imag
        C = (C_real + 1j * C_imag) * dt[:, None]
        pos = (lambda x, dt: x.to(dt))(torch.arange(L), log_dt.dtype)
        P = torch.exp((A * dt[:, None])[:, :, None] * pos[None, None, :])
        K = 2.0 * torch.einsum("dn,dnl->dl", C, P).real
        L2 = 2 * L
        u_t = (lambda x, *d: x.permute(*d))(u, 0, 2, 1)
        Kf = (lambda x, *a, **k: torch.fft.rfft(x.float(), *a, **k))(K, L2)
        Uf = (lambda x, *a, **k: torch.fft.rfft(x.float(), *a, **k))(u_t, L2)
        y = (lambda x, *a, **k: torch.fft.irfft(x, *a, **k).to(torch.bfloat16))(Uf * Kf[None, :, :], L2)[:, :, :L]
        y = (lambda x, *d: x.permute(*d))(y, 0, 2, 1)
        return y + u * D_skip[None, None, :]

    def _B_ref(x, w_r, w_gate, w_up, w_down):
        B, S, D = x.shape
        C = 1
        r = x @ w_r
        idx = torch.argsort(-r, axis=-1)[:, :C]
        idx_e = (lambda x, n, axis: torch.repeat_interleave(x, n, dim=axis))(idx.reshape(B, C, 1), D, axis=2)
        x_sel = (lambda x, i, axis: torch.take_along_dim(x, i, dim=axis))(x, idx_e, axis=1)
        g = _silu(x_sel @ w_gate)
        u = x_sel @ w_up
        y = (g * u) @ w_down
        r_sel = _sigmoid((lambda x, i, axis: torch.take_along_dim(x, i, dim=axis))(r, idx, axis=1))
        y = y * r_sel.reshape(B, C, 1)
        b_off = (torch.arange(B) * S).reshape(B, 1)
        flat_idx = (idx + b_off).reshape(B * C)
        zero = (x * 0.0).reshape(B * S, D)
        upd = _scatter_add(zero, flat_idx, y.reshape(B * C, D), axis=0)
        return x + upd.reshape(B, S, D)

    x = A_u
    xn = _layernorm(x, axis=-1)
    return x + _A_ref(xn, A_log_A_real, A_A_imag, A_C_real, A_C_imag, A_log_dt, A_D_skip) + _B_ref(xn, B_w_r, B_w_gate, B_w_up, B_w_down)
```

```asm
; @launch grid=(256,1,1) block=(768,1,1) lds=143104
.amdgcn_target "amdgcn-amd-amdhsa--gfx950"
.text
.globl parallel_sum__ssm_conv_s4d__moe_arch_mod__prompt_kernel
.p2align 8
.type parallel_sum__ssm_conv_s4d__moe_arch_mod__prompt_kernel,@function
parallel_sum__ssm_conv_s4d__moe_arch_mod__prompt_kernel:
    s_cmp_ge_u32 s2, 256
    s_cbranch_scc1 k2_end
    s_load_dwordx16 s[16:31], s[0:1], 0
    s_load_dwordx8 s[32:39], s[0:1], 64
    s_load_dwordx4 s[40:43], s[0:1], 96
    s_load_dwordx2 s[44:45], s[0:1], 112
    v_lshrrev_b32 v2, 6, v0
    v_and_b32 v1, 63, v0
    v_readfirstlane_b32 s3, v2
    s_and_b32 s4, s2, 7
    s_lshr_b32 s5, s2, 3
    s_lshl_b32 s6, s4, 5
    s_add_u32 s6, s6, s5
    s_mul_i32 s7, s4, 7
    s_lshr_b32 s8, s5, 2
    s_add_u32 s7, s7, s8
    s_and_b32 s8, s5, 3
    s_waitcnt lgkmcnt(0)
    s_mov_b32 s52, s44
    s_and_b32 s53, s45, 0xffff
    s_mov_b32 s54, 0x10000000
    s_mov_b32 s55, 0x20000
    s_cmp_ge_u32 s3, 8
    s_cbranch_scc1 k2_E
    s_cmp_ge_u32 s3, 4
    s_cbranch_scc1 k2_G
    s_mov_b32 s48, s18
    s_and_b32 s49, s19, 0xffff
    s_mov_b32 s50, 0x40000
    s_mov_b32 s51, 0x20000
    s_mov_b32 s56, s20
    s_and_b32 s57, s21, 0xffff
    s_mov_b32 s58, 0x40000
    s_mov_b32 s59, 0x20000
    s_mov_b32 s60, s22
    s_and_b32 s61, s23, 0xffff
    s_mov_b32 s62, 0x40000
    s_mov_b32 s63, 0x20000
    s_mov_b32 s64, s24
    s_and_b32 s65, s25, 0xffff
    s_mov_b32 s66, 0x40000
    s_mov_b32 s67, 0x20000
    s_mov_b32 s68, s26
    s_and_b32 s69, s27, 0xffff
    s_mov_b32 s70, 0x800
    s_mov_b32 s71, 0x20000
    s_lshl_b32 s22, s6, 2
    s_add_u32 s22, s22, s3
    s_lshl_b32 s5, s22, 8
    s_lshl_b32 s6, s22, 1
    v_lshlrev_b32 v2, 2, v1
    v_mov_b32 v3, 0
    buffer_load_ushort v12, v3, s[68:71], s6 offen
    buffer_load_dword v8, v2, s[48:51], s5 offen nt
    buffer_load_dword v9, v2, s[56:59], s5 offen nt
    buffer_load_dword v10, v2, s[60:63], s5 offen nt
    buffer_load_dword v11, v2, s[64:67], s5 offen nt
    v_mov_b32 v32, 0
    v_mov_b32 v33, 0
    v_mov_b32 v34, 0
    v_mov_b32 v35, 0
    v_lshlrev_b32 v5, 4, v1
    v_add_u32 v6, 143040, v5
    s_mov_b64 exec, 15
    ds_write_b128 v6, v[32:35]
    s_mov_b64 exec, -1
    s_waitcnt lgkmcnt(0)
    s_barrier
    s_mov_b32 s8, 0x3fb8aa3b
    s_mov_b32 s9, 0x32a57060
    s_mov_b32 s10, 0x3e22f983
    s_mov_b32 s11, 0x31dc9c88
    s_mul_i32 s7, s3, 16896
    s_add_u32 s7, s7, 53376
    v_lshlrev_b32 v4, 3, v1
    v_add_u32 v4, s7, v4
    v_and_b32 v5, 31, v1
    v_lshrrev_b32 v6, 5, v1
    v_min_u32 v7, 20, v5
    v_mul_u32_u24 v7, 528, v7
    v_lshl_add_u32 v7, v6, 4, v7
    v_add_u32 v7, s7, v7
    v_mul_u32_u24 v13, 528, v5
    v_lshl_add_u32 v13, v6, 4, v13
    v_add_u32 v13, s7, v13
    s_waitcnt vmcnt(0)
    v_lshlrev_b32 v12, 16, v12
    v_lshlrev_b32 v14, 16, v8
    v_and_b32 v15, 0xffff0000, v8
    v_mul_f32 v22, s8, v12
    v_mul_f32 v23, s8, v14
    v_mul_f32 v24, s8, v15
    v_rndne_f32 v22, v22
    v_rndne_f32 v23, v23
    v_rndne_f32 v24, v24
    v_fma_f32 v25, v12, s8, -v22
    v_fma_f32 v26, v14, s8, -v23
    v_fma_f32 v27, v15, s8, -v24
    v_fma_f32 v25, v12, s9, v25
    v_fma_f32 v26, v14, s9, v26
    v_fma_f32 v27, v15, s9, v27
    v_exp_f32 v25, v25
    v_exp_f32 v26, v26
    v_exp_f32 v27, v27
    v_cvt_i32_f32 v22, v22
    v_cvt_i32_f32 v23, v23
    v_cvt_i32_f32 v24, v24
    v_ldexp_f32 v12, v25, v22
    v_ldexp_f32 v14, v26, v23
    v_ldexp_f32 v15, v27, v24
    v_cvt_pk_bf16_f32 v12, 0, v12
    v_cvt_pk_bf16_f32 v14, 0, v14
    v_cvt_pk_bf16_f32 v15, 0, v15
    v_lshlrev_b32 v16, 16, v9
    v_and_b32 v17, 0xffff0000, v9
    v_lshlrev_b32 v18, 16, v10
    v_and_b32 v19, 0xffff0000, v10
    v_lshlrev_b32 v20, 16, v11
    v_and_b32 v21, 0xffff0000, v11
    v_mul_f32 v14, v12, v14
    v_mul_f32 v15, v12, v15
    v_mul_f32 v16, v12, v16
    v_mul_f32 v17, v12, v17
    v_mul_f32 v18, v12, v18
    v_mul_f32 v19, v12, v19
    v_mul_f32 v20, v12, v20
    v_mul_f32 v21, v12, v21
    v_mul_f32 v14, 0xbfb8aa3b, v14
    v_mul_f32 v15, 0xbfb8aa3b, v15
    v_mul_f32 v22, s10, v16
    v_mul_f32 v23, s10, v17
    v_fma_f32 v24, v16, s10, -v22
    v_fma_f32 v25, v17, s10, -v23
    v_fma_f32 v24, v16, s11, v24
    v_fma_f32 v25, v17, s11, v25
    v_rndne_f32 v26, v22
    v_rndne_f32 v27, v23
    v_sub_f32 v22, v22, v26
    v_sub_f32 v23, v23, v27
    v_add_f32 v16, v22, v24
    v_add_f32 v17, v23, v25
    v_add_f32 v28, abs(v18), abs(v19)
    v_add_f32 v29, abs(v20), abs(v21)
    v_add_f32 v28, v28, v29
    v_mul_f32 v80, 0x41000000, v14
    v_mul_f32 v82, 0x41000000, v16
    v_mul_f32 v81, 0x41000000, v15
    v_mul_f32 v83, 0x41000000, v17
    v_mul_f32 v84, 0x42800000, v14
    v_mul_f32 v86, 0x42800000, v16
    v_mul_f32 v85, 0x42800000, v15
    v_mul_f32 v87, 0x42800000, v17
    v_mul_f32 v88, 0x3f800000, v14
    v_mul_f32 v90, 0x3f800000, v16
    v_mul_f32 v89, 0x3f800000, v15
    v_mul_f32 v91, 0x3f800000, v17
    v_mul_f32 v92, 0x43800000, v14
    v_mul_f32 v94, 0x43800000, v16
    v_mul_f32 v93, 0x43800000, v15
    v_mul_f32 v95, 0x43800000, v17
    v_fract_f32 v82, v82
    v_exp_f32 v80, v80
    v_fract_f32 v83, v83
    v_exp_f32 v81, v81
    v_fract_f32 v86, v86
    v_exp_f32 v84, v84
    v_fract_f32 v87, v87
    v_exp_f32 v85, v85
    v_fract_f32 v90, v90
    v_exp_f32 v88, v88
    v_fract_f32 v91, v91
    v_exp_f32 v89, v89
    v_fract_f32 v94, v94
    v_exp_f32 v92, v92
    v_fract_f32 v95, v95
    v_exp_f32 v93, v93
    v_cos_f32 v44, v82
    v_sin_f32 v46, v82
    v_cos_f32 v45, v83
    v_sin_f32 v47, v83
    v_cos_f32 v68, v86
    v_sin_f32 v70, v86
    v_cos_f32 v69, v87
    v_sin_f32 v71, v87
    v_cos_f32 v40, v90
    v_sin_f32 v42, v90
    v_cos_f32 v41, v91
    v_sin_f32 v43, v91
    v_cos_f32 v52, v94
    v_sin_f32 v54, v94
    v_cos_f32 v53, v95
    v_sin_f32 v55, v95
    v_pk_mul_f32 v[44:45], v[44:45], v[80:81]
    v_pk_mul_f32 v[46:47], v[46:47], v[80:81]
    v_pk_mul_f32 v[68:69], v[68:69], v[84:85]
    v_pk_mul_f32 v[70:71], v[70:71], v[84:85]
    v_pk_mul_f32 v[40:41], v[40:41], v[88:89]
    v_pk_mul_f32 v[42:43], v[42:43], v[88:89]
    v_pk_mul_f32 v[52:53], v[52:53], v[92:93]
    v_pk_mul_f32 v[54:55], v[54:55], v[92:93]
    v_mov_b32 v29, v28
    s_nop 1
    v_permlane32_swap_b32 v28, v29
    v_add_f32 v28, v28, v29
    v_mov_b32 v29, v28
    s_nop 1
    v_permlane16_swap_b32 v28, v29
    v_add_f32 v28, v28, v29
    s_nop 1
    v_add_f32 v28, v28, v28 row_ror:8
    s_nop 1
    v_add_f32 v28, v28, v28 row_ror:4
    s_nop 1
    v_add_f32 v28, v28, v28 row_ror:2
    s_nop 1
    v_add_f32 v28, v28, v28 row_ror:1
    v_mov_b32 v32, 0x3c00
    v_mov_b32 v33, 0x3c00
    ds_write_b64 v4, v[32:33]
    v_pk_mul_f32 v[80:81], v[68:69], v[68:69]
    v_pk_mul_f32 v[82:83], v[68:69], v[70:71]
    v_pk_mul_f32 v[84:85], v[40:41], v[40:41]
    v_pk_mul_f32 v[86:87], v[40:41], v[42:43]
    v_pk_fma_f32 v[72:73], v[70:71], v[70:71], v[80:81] neg_lo:[1,0,0] neg_hi:[1,0,0]
    v_pk_fma_f32 v[74:75], v[70:71], v[68:69], v[82:83]
    v_pk_fma_f32 v[56:57], v[42:43], v[42:43], v[84:85] neg_lo:[1,0,0] neg_hi:[1,0,0]
    v_pk_fma_f32 v[58:59], v[42:43], v[40:41], v[86:87]
    v_cvt_pk_f16_f32 v34, v44, v46
    v_cvt_pk_f16_f32 v35, v45, v47
    ds_write_b64 v4, v[34:35] offset:528
    v_cvt_pk_f16_f32 v36, v68, v70
    v_cvt_pk_f16_f32 v37, v69, v71
    ds_write_b64 v4, v[36:37] offset:4224
    v_pk_mul_f32 v[88:89], v[72:73], v[68:69]
    v_pk_mul_f32 v[90:91], v[72:73], v[70:71]
    v_pk_mul_f32 v[92:93], v[44:45], v[44:45]
    v_pk_mul_f32 v[94:95], v[44:45], v[46:47]
    v_pk_mul_f32 v[80:81], v[56:57], v[56:57]
    v_pk_mul_f32 v[82:83], v[56:57], v[58:59]
    v_pk_fma_f32 v[76:77], v[74:75], v[70:71], v[88:89] neg_lo:[1,0,0] neg_hi:[1,0,0]
    v_pk_fma_f32 v[78:79], v[74:75], v[68:69], v[90:91]
    v_pk_fma_f32 v[64:65], v[46:47], v[46:47], v[92:93] neg_lo:[1,0,0] neg_hi:[1,0,0]
    v_pk_fma_f32 v[66:67], v[46:47], v[44:45], v[94:95]
    v_pk_fma_f32 v[60:61], v[58:59], v[58:59], v[80:81] neg_lo:[1,0,0] neg_hi:[1,0,0]
    v_pk_fma_f32 v[62:63], v[58:59], v[56:57], v[82:83]
    v_cvt_pk_f16_f32 v38, v72, v74
    v_cvt_pk_f16_f32 v39, v73, v75
    ds_write_b64 v4, v[38:39] offset:8448
    v_pk_mul_f32 v[84:85], v[68:69], v[44:45]
    v_pk_mul_f32 v[86:87], v[68:69], v[46:47]
    v_pk_mul_f32 v[88:89], v[72:73], v[44:45]
    v_pk_mul_f32 v[90:91], v[72:73], v[46:47]
    v_pk_fma_f32 v[68:69], v[70:71], v[46:47], v[84:85] neg_lo:[1,0,0] neg_hi:[1,0,0]
    v_pk_fma_f32 v[70:71], v[70:71], v[44:45], v[86:87]
    v_pk_fma_f32 v[72:73], v[74:75], v[46:47], v[88:89] neg_lo:[1,0,0] neg_hi:[1,0,0]
    v_pk_fma_f32 v[74:75], v[74:75], v[44:45], v[90:91]
    v_cvt_pk_f16_f32 v32, v76, v78
    v_cvt_pk_f16_f32 v33, v77, v79
    ds_write_b64 v4, v[32:33] offset:12672
    v_cvt_pk_f16_f32 v34, v64, v66
    v_cvt_pk_f16_f32 v35, v65, v67
    ds_write_b64 v4, v[34:35] offset:1056
    v_pk_mul_f32 v[92:93], v[76:77], v[44:45]
    v_pk_mul_f32 v[94:95], v[76:77], v[46:47]
    v_pk_fma_f32 v[76:77], v[78:79], v[46:47], v[92:93] neg_lo:[1,0,0] neg_hi:[1,0,0]
    v_pk_fma_f32 v[78:79], v[78:79], v[44:45], v[94:95]
    v_cvt_pk_f16_f32 v36, v68, v70
    v_cvt_pk_f16_f32 v37, v69, v71
    ds_write_b64 v4, v[36:37] offset:4752
    v_cvt_pk_f16_f32 v38, v72, v74
    v_cvt_pk_f16_f32 v39, v73, v75
    ds_write_b64 v4, v[38:39] offset:8976
    v_cvt_pk_f16_f32 v32, v76, v78
    v_cvt_pk_f16_f32 v33, v77, v79
    ds_write_b64 v4, v[32:33] offset:13200
    v_pk_mul_f32 v[80:81], v[64:65], v[44:45]
    v_pk_mul_f32 v[82:83], v[64:65], v[46:47]
    v_pk_mul_f32 v[84:85], v[68:69], v[44:45]
    v_pk_mul_f32 v[86:87], v[68:69], v[46:47]
    v_pk_mul_f32 v[88:89], v[72:73], v[44:45]
    v_pk_mul_f32 v[90:91], v[72:73], v[46:47]
    v_pk_mul_f32 v[92:93], v[76:77], v[44:45]
    v_pk_mul_f32 v[94:95], v[76:77], v[46:47]
    v_pk_fma_f32 v[64:65], v[66:67], v[46:47], v[80:81] neg_lo:[1,0,0] neg_hi:[1,0,0]
    v_pk_fma_f32 v[66:67], v[66:67], v[44:45], v[82:83]
    v_pk_fma_f32 v[68:69], v[70:71], v[46:47], v[84:85] neg_lo:[1,0,0] neg_hi:[1,0,0]
    v_pk_fma_f32 v[70:71], v[70:71], v[44:45], v[86:87]
    v_pk_fma_f32 v[72:73], v[74:75], v[46:47], v[88:89] neg_lo:[1,0,0] neg_hi:[1,0,0]
    v_pk_fma_f32 v[74:75], v[74:75], v[44:45], v[90:91]
    v_pk_fma_f32 v[76:77], v[78:79], v[46:47], v[92:93] neg_lo:[1,0,0] neg_hi:[1,0,0]
    v_pk_fma_f32 v[78:79], v[78:79], v[44:45], v[94:95]
    v_cvt_pk_f16_f32 v34, v64, v66
    v_cvt_pk_f16_f32 v35, v65, v67
    ds_write_b64 v4, v[34:35] offset:1584
    v_cvt_pk_f16_f32 v36, v68, v70
    v_cvt_pk_f16_f32 v37, v69, v71
    ds_write_b64 v4, v[36:37] offset:5280
    v_cvt_pk_f16_f32 v38, v72, v74
    v_cvt_pk_f16_f32 v39, v73, v75
    ds_write_b64 v4, v[38:39] offset:9504
    v_cvt_pk_f16_f32 v32, v76, v78
    v_cvt_pk_f16_f32 v33, v77, v79
    ds_write_b64 v4, v[32:33] offset:13728
    v_pk_mul_f32 v[80:81], v[64:65], v[44:45]
    v_pk_mul_f32 v[82:83], v[64:65], v[46:47]
    v_pk_mul_f32 v[84:85], v[68:69], v[44:45]
    v_pk_mul_f32 v[86:87], v[68:69], v[46:47]
    v_pk_mul_f32 v[88:89], v[72:73], v[44:45]
    v_pk_mul_f32 v[90:91], v[72:73], v[46:47]
    v_pk_mul_f32 v[92:93], v[76:77], v[44:45]
    v_pk_mul_f32 v[94:95], v[76:77], v[46:47]
    v_pk_fma_f32 v[64:65], v[66:67], v[46:47], v[80:81] neg_lo:[1,0,0] neg_hi:[1,0,0]
    v_pk_fma_f32 v[66:67], v[66:67], v[44:45], v[82:83]
    v_pk_fma_f32 v[68:69], v[70:71], v[46:47], v[84:85] neg_lo:[1,0,0] neg_hi:[1,0,0]
    v_pk_fma_f32 v[70:71], v[70:71], v[44:45], v[86:87]
    v_pk_fma_f32 v[72:73], v[74:75], v[46:47], v[88:89] neg_lo:[1,0,0] neg_hi:[1,0,0]
    v_pk_fma_f32 v[74:75], v[74:75], v[44:45], v[90:91]
    v_pk_fma_f32 v[76:77], v[78:79], v[46:47], v[92:93] neg_lo:[1,0,0] neg_hi:[1,0,0]
    v_pk_fma_f32 v[78:79], v[78:79], v[44:45], v[94:95]
    v_cvt_pk_f16_f32 v34, v64, v66
    v_cvt_pk_f16_f32 v35, v65, v67
    ds_write_b64 v4, v[34:35] offset:2112
    v_cvt_pk_f16_f32 v36, v68, v70
    v_cvt_pk_f16_f32 v37, v69, v71
    ds_write_b64 v4, v[36:37] offset:5808
    v_cvt_pk_f16_f32 v38, v72, v74
    v_cvt_pk_f16_f32 v39, v73, v75
    ds_write_b64 v4, v[38:39] offset:10032
    v_cvt_pk_f16_f32 v32, v76, v78
    v_cvt_pk_f16_f32 v33, v77, v79
    ds_write_b64 v4, v[32:33] offset:14256
    v_pk_mul_f32 v[80:81], v[64:65], v[44:45]
    v_pk_mul_f32 v[82:83], v[64:65], v[46:47]
    v_pk_mul_f32 v[84:85], v[68:69], v[44:45]
    v_pk_mul_f32 v[86:87], v[68:69], v[46:47]
    v_pk_mul_f32 v[88:89], v[72:73], v[44:45]
    v_pk_mul_f32 v[90:91], v[72:73], v[46:47]
    v_pk_mul_f32 v[92:93], v[76:77], v[44:45]
    v_pk_mul_f32 v[94:95], v[76:77], v[46:47]
    v_pk_fma_f32 v[64:65], v[66:67], v[46:47], v[80:81] neg_lo:[1,0,0] neg_hi:[1,0,0]
    v_pk_fma_f32 v[66:67], v[66:67], v[44:45], v[82:83]
    v_pk_fma_f32 v[68:69], v[70:71], v[46:47], v[84:85] neg_lo:[1,0,0] neg_hi:[1,0,0]
    v_pk_fma_f32 v[70:71], v[70:71], v[44:45], v[86:87]
    v_pk_fma_f32 v[72:73], v[74:75], v[46:47], v[88:89] neg_lo:[1,0,0] neg_hi:[1,0,0]
    v_pk_fma_f32 v[74:75], v[74:75], v[44:45], v[90:91]
    v_pk_fma_f32 v[76:77], v[78:79], v[46:47], v[92:93] neg_lo:[1,0,0] neg_hi:[1,0,0]
    v_pk_fma_f32 v[78:79], v[78:79], v[44:45], v[94:95]
    v_cvt_pk_f16_f32 v34, v64, v66
    v_cvt_pk_f16_f32 v35, v65, v67
    ds_write_b64 v4, v[34:35] offset:2640
    v_cvt_pk_f16_f32 v36, v68, v70
    v_cvt_pk_f16_f32 v37, v69, v71
    ds_write_b64 v4, v[36:37] offset:6336
    v_cvt_pk_f16_f32 v38, v72, v74
    v_cvt_pk_f16_f32 v39, v73, v75
    ds_write_b64 v4, v[38:39] offset:10560
    v_cvt_pk_f16_f32 v32, v76, v78
    v_cvt_pk_f16_f32 v33, v77, v79
    ds_write_b64 v4, v[32:33] offset:14784
    v_pk_mul_f32 v[80:81], v[64:65], v[44:45]
    v_pk_mul_f32 v[82:83], v[64:65], v[46:47]
    v_pk_mul_f32 v[84:85], v[68:69], v[44:45]
    v_pk_mul_f32 v[86:87], v[68:69], v[46:47]
    v_pk_mul_f32 v[88:89], v[72:73], v[44:45]
    v_pk_mul_f32 v[90:91], v[72:73], v[46:47]
    v_pk_mul_f32 v[92:93], v[76:77], v[44:45]
    v_pk_mul_f32 v[94:95], v[76:77], v[46:47]
    v_pk_fma_f32 v[64:65], v[66:67], v[46:47], v[80:81] neg_lo:[1,0,0] neg_hi:[1,0,0]
    v_pk_fma_f32 v[66:67], v[66:67], v[44:45], v[82:83]
    v_pk_fma_f32 v[68:69], v[70:71], v[46:47], v[84:85] neg_lo:[1,0,0] neg_hi:[1,0,0]
    v_pk_fma_f32 v[70:71], v[70:71], v[44:45], v[86:87]
    v_pk_fma_f32 v[72:73], v[74:75], v[46:47], v[88:89] neg_lo:[1,0,0] neg_hi:[1,0,0]
    v_pk_fma_f32 v[74:75], v[74:75], v[44:45], v[90:91]
    v_pk_fma_f32 v[76:77], v[78:79], v[46:47], v[92:93] neg_lo:[1,0,0] neg_hi:[1,0,0]
    v_pk_fma_f32 v[78:79], v[78:79], v[44:45], v[94:95]
    v_cvt_pk_f16_f32 v34, v64, v66
    v_cvt_pk_f16_f32 v35, v65, v67
    ds_write_b64 v4, v[34:35] offset:3168
    v_cvt_pk_f16_f32 v36, v68, v70
    v_cvt_pk_f16_f32 v37, v69, v71
    ds_write_b64 v4, v[36:37] offset:6864
    v_cvt_pk_f16_f32 v38, v72, v74
    v_cvt_pk_f16_f32 v39, v73, v75
    ds_write_b64 v4, v[38:39] offset:11088
    v_cvt_pk_f16_f32 v32, v76, v78
    v_cvt_pk_f16_f32 v33, v77, v79
    ds_write_b64 v4, v[32:33] offset:15312
    v_pk_mul_f32 v[80:81], v[64:65], v[44:45]
    v_pk_mul_f32 v[82:83], v[64:65], v[46:47]
    v_pk_mul_f32 v[84:85], v[68:69], v[44:45]
    v_pk_mul_f32 v[86:87], v[68:69], v[46:47]
    v_pk_mul_f32 v[88:89], v[72:73], v[44:45]
    v_pk_mul_f32 v[90:91], v[72:73], v[46:47]
    v_pk_mul_f32 v[92:93], v[76:77], v[44:45]
    v_pk_mul_f32 v[94:95], v[76:77], v[46:47]
    v_pk_fma_f32 v[64:65], v[66:67], v[46:47], v[80:81] neg_lo:[1,0,0] neg_hi:[1,0,0]
    v_pk_fma_f32 v[66:67], v[66:67], v[44:45], v[82:83]
    v_pk_fma_f32 v[68:69], v[70:71], v[46:47], v[84:85] neg_lo:[1,0,0] neg_hi:[1,0,0]
    v_pk_fma_f32 v[70:71], v[70:71], v[44:45], v[86:87]
    v_pk_fma_f32 v[72:73], v[74:75], v[46:47], v[88:89] neg_lo:[1,0,0] neg_hi:[1,0,0]
    v_pk_fma_f32 v[74:75], v[74:75], v[44:45], v[90:91]
    v_pk_fma_f32 v[76:77], v[78:79], v[46:47], v[92:93] neg_lo:[1,0,0] neg_hi:[1,0,0]
    v_pk_fma_f32 v[78:79], v[78:79], v[44:45], v[94:95]
    v_cvt_pk_f16_f32 v34, v64, v66
    v_cvt_pk_f16_f32 v35, v65, v67
    ds_write_b64 v4, v[34:35] offset:3696
    v_cvt_pk_f16_f32 v36, v68, v70
    v_cvt_pk_f16_f32 v37, v69, v71
    ds_write_b64 v4, v[36:37] offset:7392
    v_cvt_pk_f16_f32 v38, v72, v74
    v_cvt_pk_f16_f32 v39, v73, v75
    ds_write_b64 v4, v[38:39] offset:11616
    v_cvt_pk_f16_f32 v32, v76, v78
    v_cvt_pk_f16_f32 v33, v77, v79
    ds_write_b64 v4, v[32:33] offset:15840
    v_pk_mul_f32 v[80:81], v[68:69], v[44:45]
    v_pk_mul_f32 v[82:83], v[68:69], v[46:47]
    v_pk_mul_f32 v[84:85], v[72:73], v[44:45]
    v_pk_mul_f32 v[86:87], v[72:73], v[46:47]
    v_pk_mul_f32 v[88:89], v[76:77], v[44:45]
    v_pk_mul_f32 v[90:91], v[76:77], v[46:47]
    v_pk_fma_f32 v[68:69], v[70:71], v[46:47], v[80:81] neg_lo:[1,0,0] neg_hi:[1,0,0]
    v_pk_fma_f32 v[70:71], v[70:71], v[44:45], v[82:83]
    v_pk_fma_f32 v[72:73], v[74:75], v[46:47], v[84:85] neg_lo:[1,0,0] neg_hi:[1,0,0]
    v_pk_fma_f32 v[74:75], v[74:75], v[44:45], v[86:87]
    v_pk_fma_f32 v[76:77], v[78:79], v[46:47], v[88:89] neg_lo:[1,0,0] neg_hi:[1,0,0]
    v_pk_fma_f32 v[78:79], v[78:79], v[44:45], v[90:91]
    v_cvt_pk_f16_f32 v34, v68, v70
    v_cvt_pk_f16_f32 v35, v69, v71
    ds_write_b64 v4, v[34:35] offset:7920
    v_cvt_pk_f16_f32 v36, v72, v74
    v_cvt_pk_f16_f32 v37, v73, v75
    ds_write_b64 v4, v[36:37] offset:12144
    v_cvt_pk_f16_f32 v38, v76, v78
    v_cvt_pk_f16_f32 v39, v77, v79
    ds_write_b64 v4, v[38:39] offset:16368
    ds_read_b128 v[96:99], v13 offset:0
    ds_read_b128 v[100:103], v13 offset:32
    ds_read_b128 v[104:107], v13 offset:64
    ds_read_b128 v[108:111], v13 offset:96
    ds_read_b128 v[112:115], v13 offset:128
    ds_read_b128 v[116:119], v13 offset:160
    ds_read_b128 v[120:123], v13 offset:192
    ds_read_b128 v[124:127], v13 offset:224
    ds_read_b128 v[128:131], v13 offset:256
    ds_read_b128 v[132:135], v13 offset:288
    ds_read_b128 v[136:139], v13 offset:320
    ds_read_b128 v[140:143], v13 offset:352
    ds_read_b128 v[144:147], v13 offset:384
    ds_read_b128 v[148:151], v13 offset:416
    ds_read_b128 v[152:155], v13 offset:448
    ds_read_b128 v[156:159], v13 offset:480
    v_lshrrev_b32 v28, 23, v28
    v_add_u32 v28, 1, v28
    v_max_u32 v28, 20, v28
    v_min_u32 v28, 255, v28
    v_sub_u32 v29, 268, v28
    v_lshlrev_b32 v29, 23, v29
    v_subrev_u32 v30, 13, v28
    v_lshlrev_b32 v30, 23, v30
    s_nop 0
    v_readfirstlane_b32 s23, v30
    v_mul_f32 v64, v29, v18
    v_mul_f32 v65, v29, v19
    v_mul_f32 v66, v29, v20
    v_mul_f32 v67, v29, v21
    v_cvt_pk_f16_f32 v32, v64, -v66
    v_cvt_pk_f16_f32 v33, v65, -v67
    ds_write_b64 v4, v[32:33] offset:0
    v_pk_mul_f32 v[92:93], v[64:65], v[40:41]
    v_pk_mul_f32 v[94:95], v[64:65], v[42:43]
    v_pk_mul_f32 v[80:81], v[64:65], v[52:53]
    v_pk_mul_f32 v[82:83], v[64:65], v[54:55]
    v_pk_fma_f32 v[68:69], v[66:67], v[42:43], v[92:93] neg_lo:[1,0,0] neg_hi:[1,0,0]
    v_pk_fma_f32 v[70:71], v[66:67], v[40:41], v[94:95]
    v_pk_fma_f32 v[44:45], v[66:67], v[54:55], v[80:81] neg_lo:[1,0,0] neg_hi:[1,0,0]
    v_pk_fma_f32 v[46:47], v[66:67], v[52:53], v[82:83]
    v_cvt_pk_f16_f32 v34, v68, -v70
    v_cvt_pk_f16_f32 v35, v69, -v71
    ds_write_b64 v4, v[34:35] offset:528
    v_cvt_pk_f16_f32 v36, v44, -v46
    v_cvt_pk_f16_f32 v37, v45, -v47
    ds_write_b64 v4, v[36:37] offset:4224
    v_pk_mul_f32 v[84:85], v[68:69], v[40:41]
    v_pk_mul_f32 v[86:87], v[68:69], v[42:43]
    v_pk_mul_f32 v[88:89], v[44:45], v[56:57]
    v_pk_mul_f32 v[90:91], v[44:45], v[58:59]
    v_pk_mul_f32 v[92:93], v[44:45], v[52:53]
    v_pk_mul_f32 v[94:95], v[44:45], v[54:55]
    v_pk_fma_f32 v[68:69], v[70:71], v[42:43], v[84:85] neg_lo:[1,0,0] neg_hi:[1,0,0]
    v_pk_fma_f32 v[70:71], v[70:71], v[40:41], v[86:87]
    v_pk_fma_f32 v[72:73], v[46:47], v[58:59], v[88:89] neg_lo:[1,0,0] neg_hi:[1,0,0]
    v_pk_fma_f32 v[74:75], v[46:47], v[56:57], v[90:91]
    v_pk_fma_f32 v[64:65], v[46:47], v[54:55], v[92:93] neg_lo:[1,0,0] neg_hi:[1,0,0]
    v_pk_fma_f32 v[66:67], v[46:47], v[52:53], v[94:95]
    v_cvt_pk_f16_f32 v38, v68, -v70
    v_cvt_pk_f16_f32 v39, v69, -v71
    ds_write_b64 v4, v[38:39] offset:1056
    v_cvt_pk_f16_f32 v32, v72, -v74
    v_cvt_pk_f16_f32 v33, v73, -v75
    ds_write_b64 v4, v[32:33] offset:4752
    v_cvt_pk_f16_f32 v34, v64, -v66
    v_cvt_pk_f16_f32 v35, v65, -v67
    ds_write_b64 v4, v[34:35] offset:6336
    v_pk_mul_f32 v[80:81], v[68:69], v[40:41]
    v_pk_mul_f32 v[82:83], v[68:69], v[42:43]
    v_pk_mul_f32 v[84:85], v[72:73], v[56:57]
    v_pk_mul_f32 v[86:87], v[72:73], v[58:59]
    v_pk_mul_f32 v[88:89], v[64:65], v[60:61]
    v_pk_mul_f32 v[90:91], v[64:65], v[62:63]
    v_pk_mul_f32 v[92:93], v[64:65], v[52:53]
    v_pk_mul_f32 v[94:95], v[64:65], v[54:55]
    v_pk_fma_f32 v[68:69], v[70:71], v[42:43], v[80:81] neg_lo:[1,0,0] neg_hi:[1,0,0]
    v_pk_fma_f32 v[70:71], v[70:71], v[40:41], v[82:83]
    v_pk_fma_f32 v[72:73], v[74:75], v[58:59], v[84:85] neg_lo:[1,0,0] neg_hi:[1,0,0]
    v_pk_fma_f32 v[74:75], v[74:75], v[56:57], v[86:87]
    v_pk_fma_f32 v[76:77], v[66:67], v[62:63], v[88:89] neg_lo:[1,0,0] neg_hi:[1,0,0]
    v_pk_fma_f32 v[78:79], v[66:67], v[60:61], v[90:91]
    v_pk_fma_f32 v[44:45], v[66:67], v[54:55], v[92:93] neg_lo:[1,0,0] neg_hi:[1,0,0]
    v_pk_fma_f32 v[46:47], v[66:67], v[52:53], v[94:95]
    v_cvt_pk_f16_f32 v36, v68, -v70
    v_cvt_pk_f16_f32 v37, v69, -v71
    ds_write_b64 v4, v[36:37] offset:1584
    v_cvt_pk_f16_f32 v38, v72, -v74
    v_cvt_pk_f16_f32 v39, v73, -v75
    ds_write_b64 v4, v[38:39] offset:5280
    v_cvt_pk_f16_f32 v32, v76, -v78
    v_cvt_pk_f16_f32 v33, v77, -v79
    ds_write_b64 v4, v[32:33] offset:6864
    v_cvt_pk_f16_f32 v34, v44, -v46
    v_cvt_pk_f16_f32 v35, v45, -v47
    ds_write_b64 v4, v[34:35] offset:7392
    v_pk_mul_f32 v[80:81], v[68:69], v[40:41]
    v_pk_mul_f32 v[82:83], v[68:69], v[42:43]
    v_pk_mul_f32 v[84:85], v[72:73], v[56:57]
    v_pk_mul_f32 v[86:87], v[72:73], v[58:59]
    v_pk_mul_f32 v[88:89], v[44:45], v[60:61]
    v_pk_mul_f32 v[90:91], v[44:45], v[62:63]
    v_pk_mul_f32 v[92:93], v[44:45], v[52:53]
    v_pk_mul_f32 v[94:95], v[44:45], v[54:55]
    v_pk_fma_f32 v[68:69], v[70:71], v[42:43], v[80:81] neg_lo:[1,0,0] neg_hi:[1,0,0]
    v_pk_fma_f32 v[70:71], v[70:71], v[40:41], v[82:83]
    v_pk_fma_f32 v[72:73], v[74:75], v[58:59], v[84:85] neg_lo:[1,0,0] neg_hi:[1,0,0]
    v_pk_fma_f32 v[74:75], v[74:75], v[56:57], v[86:87]
    v_pk_fma_f32 v[76:77], v[46:47], v[62:63], v[88:89] neg_lo:[1,0,0] neg_hi:[1,0,0]
    v_pk_fma_f32 v[78:79], v[46:47], v[60:61], v[90:91]
    v_pk_fma_f32 v[64:65], v[46:47], v[54:55], v[92:93] neg_lo:[1,0,0] neg_hi:[1,0,0]
    v_pk_fma_f32 v[66:67], v[46:47], v[52:53], v[94:95]
    v_cvt_pk_f16_f32 v36, v68, -v70
    v_cvt_pk_f16_f32 v37, v69, -v71
    ds_write_b64 v4, v[36:37] offset:2112
    v_cvt_pk_f16_f32 v38, v72, -v74
    v_cvt_pk_f16_f32 v39, v73, -v75
    ds_write_b64 v4, v[38:39] offset:5808
    v_cvt_pk_f16_f32 v32, v76, -v78
    v_cvt_pk_f16_f32 v33, v77, -v79
    ds_write_b64 v4, v[32:33] offset:7920
    v_cvt_pk_f16_f32 v34, v64, -v66
    v_cvt_pk_f16_f32 v35, v65, -v67
    ds_write_b64 v4, v[34:35] offset:8448
    v_pk_mul_f32 v[80:81], v[68:69], v[40:41]
    v_pk_mul_f32 v[82:83], v[68:69], v[42:43]
    v_pk_mul_f32 v[84:85], v[64:65], v[52:53]
    v_pk_mul_f32 v[86:87], v[64:65], v[54:55]
    v_pk_fma_f32 v[68:69], v[70:71], v[42:43], v[80:81] neg_lo:[1,0,0] neg_hi:[1,0,0]
    v_pk_fma_f32 v[70:71], v[70:71], v[40:41], v[82:83]
    v_pk_fma_f32 v[64:65], v[66:67], v[54:55], v[84:85] neg_lo:[1,0,0] neg_hi:[1,0,0]
    v_pk_fma_f32 v[66:67], v[66:67], v[52:53], v[86:87]
    v_cvt_pk_f16_f32 v36, v68, -v70
    v_cvt_pk_f16_f32 v37, v69, -v71
    ds_write_b64 v4, v[36:37] offset:2640
    v_cvt_pk_f16_f32 v38, v64, -v66
    v_cvt_pk_f16_f32 v39, v65, -v67
    ds_write_b64 v4, v[38:39] offset:8976
    v_pk_mul_f32 v[88:89], v[68:69], v[40:41]
    v_pk_mul_f32 v[90:91], v[68:69], v[42:43]
    v_pk_mul_f32 v[92:93], v[64:65], v[52:53]
    v_pk_mul_f32 v[94:95], v[64:65], v[54:55]
    v_pk_fma_f32 v[68:69], v[70:71], v[42:43], v[88:89] neg_lo:[1,0,0] neg_hi:[1,0,0]
    v_pk_fma_f32 v[70:71], v[70:71], v[40:41], v[90:91]
    v_pk_fma_f32 v[64:65], v[66:67], v[54:55], v[92:93] neg_lo:[1,0,0] neg_hi:[1,0,0]
    v_pk_fma_f32 v[66:67], v[66:67], v[52:53], v[94:95]
    v_cvt_pk_f16_f32 v32, v68, -v70
    v_cvt_pk_f16_f32 v33, v69, -v71
    ds_write_b64 v4, v[32:33] offset:3168
    v_cvt_pk_f16_f32 v34, v64, -v66
    v_cvt_pk_f16_f32 v35, v65, -v67
    ds_write_b64 v4, v[34:35] offset:9504
    v_pk_mul_f32 v[80:81], v[68:69], v[40:41]
    v_pk_mul_f32 v[82:83], v[68:69], v[42:43]
    v_pk_mul_f32 v[84:85], v[64:65], v[52:53]
    v_pk_mul_f32 v[86:87], v[64:65], v[54:55]
    v_pk_fma_f32 v[68:69], v[70:71], v[42:43], v[80:81] neg_lo:[1,0,0] neg_hi:[1,0,0]
    v_pk_fma_f32 v[70:71], v[70:71], v[40:41], v[82:83]
    v_pk_fma_f32 v[64:65], v[66:67], v[54:55], v[84:85] neg_lo:[1,0,0] neg_hi:[1,0,0]
    v_pk_fma_f32 v[66:67], v[66:67], v[52:53], v[86:87]
    v_cvt_pk_f16_f32 v36, v68, -v70
    v_cvt_pk_f16_f32 v37, v69, -v71
    ds_write_b64 v4, v[36:37] offset:3696
    v_cvt_pk_f16_f32 v38, v64, -v66
    v_cvt_pk_f16_f32 v39, v65, -v67
    ds_write_b64 v4, v[38:39] offset:10032
    v_pk_mul_f32 v[88:89], v[64:65], v[52:53]
    v_pk_mul_f32 v[90:91], v[64:65], v[54:55]
    v_pk_fma_f32 v[64:65], v[66:67], v[54:55], v[88:89] neg_lo:[1,0,0] neg_hi:[1,0,0]
    v_pk_fma_f32 v[66:67], v[66:67], v[52:53], v[90:91]
    v_cvt_pk_f16_f32 v32, v64, -v66
    v_cvt_pk_f16_f32 v33, v65, -v67
    ds_write_b64 v4, v[32:33] offset:10560
    s_waitcnt lgkmcnt(0)
    ds_read_b128 v[64:67], v7 offset:0
    ds_read_b128 v[68:71], v7 offset:32
    ds_read_b128 v[72:75], v7 offset:64
    ds_read_b128 v[76:79], v7 offset:96
    ds_read_b128 v[80:83], v7 offset:128
    ds_read_b128 v[84:87], v7 offset:160
    ds_read_b128 v[88:91], v7 offset:192
    ds_read_b128 v[92:95], v7 offset:224
    v_lshlrev_b32 v8, 4, v5
    v_lshl_add_u32 v9, v6, 3, v8
    s_add_u32 s12, s7, 1080
    v_sub_u32 v9, s12, v9
    s_add_u32 s12, s7, 560
    v_sub_u32 v10, s12, v8
    s_add_u32 s12, s7, 48
    v_sub_u32 v11, s12, v8
    v_lshlrev_b32 v12, 2, v5
    v_add_u32 v12, s7, v12
    v_lshlrev_b32 v13, 1, v5
    v_add_u32 v13, s7, v13
    v_mov_b32 v3, s7
    v_lshlrev_b32 v15, 4, v1
    v_add_u32 v15, s7, v15
    v_mov_b32 v56, 0
    v_mov_b32 v57, 0
    v_mov_b32 v58, 0
    v_mov_b32 v59, 0
    s_waitcnt lgkmcnt(7)
    v_mfma_f32_32x32x16_f16 v[16:31], v[64:67], v[96:99], 0
    ds_read_b128 v[64:67], v7 offset:256
    s_waitcnt lgkmcnt(7)
    v_mfma_f32_32x32x16_f16 v[16:31], v[68:71], v[100:103], v[16:31]
    ds_read_b128 v[68:71], v7 offset:288
    s_waitcnt lgkmcnt(7)
    v_mfma_f32_32x32x16_f16 v[16:31], v[72:75], v[104:107], v[16:31]
    ds_read_b128 v[72:75], v7 offset:320
    s_waitcnt lgkmcnt(7)
    v_mfma_f32_32x32x16_f16 v[16:31], v[76:79], v[108:111], v[16:31]
    ds_read_b128 v[76:79], v7 offset:352
    s_waitcnt lgkmcnt(7)
    v_mfma_f32_32x32x16_f16 v[16:31], v[80:83], v[112:115], v[16:31]
    ds_read_b128 v[80:83], v7 offset:384
    s_waitcnt lgkmcnt(7)
    v_mfma_f32_32x32x16_f16 v[16:31], v[84:87], v[116:119], v[16:31]
    ds_read_b128 v[84:87], v7 offset:416
    s_waitcnt lgkmcnt(7)
    v_mfma_f32_32x32x16_f16 v[16:31], v[88:91], v[120:123], v[16:31]
    ds_read_b128 v[88:91], v7 offset:448
    s_waitcnt lgkmcnt(7)
    v_mfma_f32_32x32x16_f16 v[16:31], v[92:95], v[124:127], v[16:31]
    ds_read_b128 v[92:95], v7 offset:480
    s_waitcnt lgkmcnt(7)
    v_mfma_f32_32x32x16_f16 v[16:31], v[64:67], v[128:131], v[16:31]
    s_waitcnt lgkmcnt(6)
    v_mfma_f32_32x32x16_f16 v[16:31], v[68:71], v[132:135], v[16:31]
    s_waitcnt lgkmcnt(5)
    v_mfma_f32_32x32x16_f16 v[16:31], v[72:75], v[136:139], v[16:31]
    s_waitcnt lgkmcnt(4)
    v_mfma_f32_32x32x16_f16 v[16:31], v[76:79], v[140:143], v[16:31]
    s_waitcnt lgkmcnt(3)
    v_mfma_f32_32x32x16_f16 v[16:31], v[80:83], v[144:147], v[16:31]
    s_waitcnt lgkmcnt(2)
    v_mfma_f32_32x32x16_f16 v[16:31], v[84:87], v[148:151], v[16:31]
    s_waitcnt lgkmcnt(1)
    v_mfma_f32_32x32x16_f16 v[16:31], v[88:91], v[152:155], v[16:31]
    s_waitcnt lgkmcnt(0)
    v_mfma_f32_32x32x16_f16 v[16:31], v[92:95], v[156:159], v[16:31]
    ds_write_b128 v15, v[56:59]
    ds_write_b128 v15, v[56:59] offset:1024
    v_mov_b32 v6, 143040
    v_mov_b32 v7, 1
    v_mov_b32 v14, 0
    v_cmp_ne_u32 vcc, 33, v1
    s_nop 5
    v_mov_b32 v14, v20 wave_shl:1
    v_cvt_pk_f16_f32 v40, v19, v18
    v_cvt_pk_f16_f32 v41, v17, v16
    ds_write_b64 v9, v[40:41]
    v_cvt_pk_f16_f32 v44, v14, v23
    v_cvt_pk_f16_f32 v45, v22, v22
    v_cvt_pk_f16_f32 v46, v22, v21
    v_cvt_pk_f16_f32 v47, v20, v20
    v_cvt_pk_f16_f32 v48, v14, v14
    v_cvt_pk_f16_f32 v49, v21, v21
    v_cvt_pk_f16_f32 v50, v21, v20
    v_mov_b32 v51, v47
    v_cndmask_b32 v48, 0, v48, vcc
    v_cvt_pk_f16_f32 v52, v20, v21
    v_cvt_pk_f16_f32 v53, v22, v23
    v_cvt_pk_f16_f32 v54, v24, v25
    v_cvt_pk_f16_f32 v55, v26, v27
    s_mov_b32 exec_hi, 0
    ds_write_b128 v10, v[44:47]
    ds_write_b16_d16_hi v13, v54 offset:1738
    ds_write_b16 v13, v55 offset:1802
    ds_write_b16_d16_hi v13, v55 offset:1866
    s_mov_b32 exec_lo, -2
    ds_write_b16 v13, v54 offset:1674
    s_mov_b32 exec_lo, 1
    ds_write_b16 v3, v54 offset:1472
    ds_write_b16 v3, v54 offset:1990
    ds_write_b16 v3, v54 offset:1992
    s_mov_b32 exec_lo, 0
    s_mov_b32 exec_hi, -1
    ds_write_b32 v12, v53 offset:1344
    s_mov_b32 exec_hi, -4
    ds_write_b32 v12, v52 offset:1216
    s_mov_b32 exec_hi, 3
    ds_write_b128 v11, v[48:51]
    s_mov_b32 exec_hi, 1
    ds_write_b16 v3, v54 offset:1930
    s_mov_b64 exec, -1
    s_mov_b32 s11, s23
    s_lshl_b32 s15, s22, 12
    s_mul_i32 s9, s3, 13328
    v_lshlrev_b32 v24, 4, v1
    v_sub_u32 v25, 1072, v24
    v_and_b32 v36, 15, v1
    v_lshrrev_b32 v37, 4, v1
    v_lshlrev_b32 v38, 3, v37
    v_sub_u32 v38, v38, v36
    v_lshlrev_b32 v26, 1, v38
    v_add_u32 v26, 30, v26
    v_lshlrev_b32 v39, 2, v37
    v_sub_u32 v39, v36, v39
    v_add_u32 v39, 12, v39
    v_lshlrev_b32 v27, 3, v39
    v_lshlrev_b32 v23, 2, v39
    v_add_u32 v25, s7, v25
    v_add_u32 v26, s7, v26
    v_add_u32 v27, s7, v27
    s_add_u32 s12, s7, 1416
    v_add_u32 v23, s12, v23
    s_waitcnt lgkmcnt(0)
    ds_read_b128 v[96:99], v25
    ds_read_b128 v[100:103], v25 offset:16
    ds_read_b64 v[56:57], v27 offset:1120
    ds_read_b64 v[58:59], v27 offset:1128
    ds_read_b64 v[60:61], v27 offset:1104
    ds_read_b64 v[62:63], v27 offset:1112
    ds_read_b64 v[64:65], v27 offset:1248
    ds_read_b64 v[66:67], v27 offset:1256
    ds_read_b64 v[68:69], v27 offset:1232
    ds_read_b64 v[70:71], v27 offset:1240
    ds_read_b64 v[72:73], v27 offset:1376
    ds_read_b64 v[74:75], v27 offset:1384
    ds_read_b64 v[76:77], v27 offset:1360
    ds_read_b64 v[78:79], v27 offset:1368
    ds_read2_b32 v[80:81], v23 offset0:50 offset1:51
    ds_read2_b32 v[82:83], v23 offset0:52 offset1:53
    ds_read2_b32 v[84:85], v23 offset0:66 offset1:67
    ds_read2_b32 v[86:87], v23 offset0:68 offset1:69
    ds_read2_b32 v[88:89], v23 offset0:82 offset1:83
    ds_read2_b32 v[90:91], v23 offset0:84 offset1:85
    ds_read2_b32 v[92:93], v23 offset0:98 offset1:99
    ds_read2_b32 v[94:95], v23 offset0:100 offset1:101
    ds_read_b128 v[160:163], v26
    ds_read_b128 v[164:167], v26 offset:1936
    s_waitcnt lgkmcnt(0)
    s_mov_b64 exec, 1
    ds_add_u32 v6, v7 offset:44
    s_mov_b64 exec, -1
    v_mov_b32 v32, 0
    v_mov_b32 v33, 0
    v_mov_b32 v34, 0
    v_mov_b32 v35, 0
    v_add_u32 v29, s9, v24
    v_mul_u32_u24 v30, 1088, v1
    v_add_u32 v30, s9, v30
    v_and_b32 v4, 7, v36
    v_mul_u32_u24 v4, 1088, v4
    v_lshrrev_b32 v39, 3, v36
    v_sub_u32 v39, v39, v37
    v_add_u32 v39, 3, v39
    v_lshl_add_u32 v4, v39, 4, v4
    s_add_u32 s12, s9, 4608
    v_add_u32 v4, s12, v4
    v_lshlrev_b32 v2, 5, v36
    v_lshl_add_u32 v2, v37, 4, v2
    s_add_u32 s12, s9, 32
    v_add_u32 v2, s12, v2
    v_lshlrev_b32 v3, 5, v36
    v_lshl_add_u32 v3, v37, 3, v3
    v_add_u32 v31, 137344, v24
    s_nop 4
k2_clf:
    ds_read_b32 v28, v6 offset:52
    s_waitcnt lgkmcnt(0)
    v_readfirstlane_b32 s14, v28
    s_cmp_ge_u32 s14, 4
    s_cbranch_scc1 k2_clf_done
    s_sleep 1
    s_branch k2_clf
k2_clf_done:
    s_nop 0
    s_mov_b32 exec_hi, 0
    ds_write_b128 v29, v[32:35] offset:0
    s_mov_b32 exec_lo, 0xff
    ds_write_b128 v30, v[32:35] offset:4608
    s_mov_b64 exec, -1
k2_cpt:
    ds_read_b32 v28, v6 offset:48
    s_waitcnt lgkmcnt(0)
    v_readfirstlane_b32 s14, v28
    s_cmp_ge_u32 s14, 4
    s_cbranch_scc1 k2_cpt_done
    s_sleep 1
    s_branch k2_cpt
k2_cpt_done:
    s_nop 0
    ds_read_b128 v[40:43], v31 offset:0
    ds_read_b128 v[44:47], v31 offset:1024
    ds_read_b128 v[48:51], v31 offset:2048
    ds_read_b128 v[52:55], v31 offset:3072
    s_add_u32 s12, s9, 4624
    v_add_u32 v30, s12, v24
    v_alignbit_b32 v104, v97, v96, 16
    v_alignbit_b32 v105, v98, v97, 16
    v_alignbit_b32 v106, v99, v98, 16
    v_alignbit_b32 v107, v100, v99, 16
    v_alignbit_b32 v108, v101, v100, 16
    v_alignbit_b32 v109, v102, v101, 16
    v_alignbit_b32 v110, v103, v102, 16
    v_mov_b32 v112, v97
    v_mov_b32 v113, v98
    v_mov_b32 v114, v99
    v_mov_b32 v115, v100
    v_mov_b32 v116, v101
    v_mov_b32 v117, v102
    v_alignbit_b32 v120, v98, v97, 16
    v_alignbit_b32 v121, v99, v98, 16
    v_alignbit_b32 v122, v100, v99, 16
    v_alignbit_b32 v123, v101, v100, 16
    v_alignbit_b32 v124, v102, v101, 16
    v_alignbit_b32 v125, v103, v102, 16
    ds_write_b128 v30, v[96:99] offset:7616
    ds_write_b128 v30, v[112:115] offset:5440
    ds_write_b128 v30, v[98:101] offset:3264
    ds_write_b128 v30, v[114:117] offset:1088
    ds_write_b128 v30, v[104:107] offset:6528
    ds_write_b128 v30, v[120:123] offset:4352
    ds_write_b128 v30, v[106:109] offset:2176
    ds_write_b128 v30, v[122:125] offset:0
    s_waitcnt vmcnt(0) lgkmcnt(0)
k2_cst:
    ds_read_b32 v7, v6 offset:0
    s_waitcnt lgkmcnt(0)
    v_readfirstlane_b32 s14, v7
    s_cmp_ge_u32 s14, 4
    s_cbranch_scc1 k2_cst_done
    s_sleep 1
    s_branch k2_cst
k2_cst_done:
    s_nop 0
    v_mov_b32 v7, 1
    s_mov_b32 s20, 0xffff
    s_mov_b32 s21, 0xffff
    ds_read_b128 v[144:147], v2 offset:432
    ds_read_b128 v[148:151], v2 offset:416
    ds_read_b128 v[152:155], v2 offset:448
    s_waitcnt lgkmcnt(2)
    v_mfma_f32_16x16x32_f16 v[96:99], v[144:147], v[40:43], 0
    v_mfma_f32_16x16x32_f16 v[100:103], v[144:147], v[44:47], 0
    s_waitcnt lgkmcnt(1)
    v_mfma_f32_16x16x32_f16 v[104:107], v[148:151], v[40:43], 0
    v_mfma_f32_16x16x32_f16 v[108:111], v[148:151], v[44:47], 0
    ds_read_b128 v[148:151], v2 offset:928
    v_mfma_f32_16x16x32_f16 v[112:115], v[144:147], v[48:51], 0
    ds_read_b128 v[144:147], v2 offset:944
    s_waitcnt lgkmcnt(2)
    v_mfma_f32_16x16x32_f16 v[116:119], v[152:155], v[52:55], 0
    v_cvt_pk_f16_f32 v120, v97, v101
    s_nop 1
    v_cvt_pk_f16_f32 v121, v105, v109
    v_cvt_pk_f16_f32 v122, v96, v100
    v_cvt_pk_f16_f32 v123, v104, v108
    v_cvt_pk_f16_f32 v124, v99, v103
    v_cvt_pk_f16_f32 v125, v107, v111
    v_cvt_pk_f16_f32 v126, v98, v102
    v_cvt_pk_f16_f32 v127, v106, v110
    v_cvt_pk_f16_f32 v128, v119, v115
    v_cvt_pk_f16_f32 v129, v118, v114
    v_cvt_pk_f16_f32 v130, v117, v113
    v_cvt_pk_f16_f32 v131, v116, v112
    ds_read_b128 v[152:155], v2 offset:960
    s_waitcnt lgkmcnt(1)
    v_mfma_f32_16x16x32_f16 v[96:99], v[144:147], v[40:43], 0
    v_mfma_f32_16x16x32_f16 v[100:103], v[144:147], v[44:47], 0
    v_mfma_f32_16x16x32_f16 v[104:107], v[148:151], v[40:43], 0
    v_mfma_f32_16x16x32_f16 v[108:111], v[148:151], v[44:47], 0
    ds_read_b128 v[148:151], v2 offset:1440
    v_mfma_f32_16x16x32_f16 v[112:115], v[144:147], v[48:51], 0
    ds_read_b128 v[144:147], v2 offset:1456
    s_waitcnt lgkmcnt(2)
    v_mfma_f32_16x16x32_f16 v[116:119], v[152:155], v[52:55], 0
    ds_read_b128 v[152:155], v2 offset:1472
    v_mfma_f32_16x16x32_f16 v[16:19], v[120:123], v[56:59], 0
    v_mfma_f32_16x16x32_f16 v[16:19], v[124:127], v[60:63], v[16:19]
    v_cvt_pk_f16_f32 v132, v97, v101
    v_cvt_pk_f16_f32 v134, v96, v100
    ds_read_b128 v[156:159], v4 offset:896
    v_mfma_f32_16x16x32_f16 v[20:23], v[120:123], v[64:67], 0
    v_cvt_pk_f16_f32 v136, v99, v103
    v_cvt_pk_f16_f32 v138, v98, v102
    v_mfma_f32_16x16x32_f16 v[20:23], v[124:127], v[68:71], v[20:23]
    v_cvt_pk_f16_f32 v133, v105, v109
    v_cvt_pk_f16_f32 v135, v104, v108
    v_mfma_f32_16x16x32_f16 v[24:27], v[120:123], v[72:75], 0
    v_cvt_pk_f16_f32 v137, v107, v111
    v_cvt_pk_f16_f32 v139, v106, v110
    v_mfma_f32_16x16x32_f16 v[24:27], v[124:127], v[76:79], v[24:27]
    v_cvt_pk_f16_f32 v140, v119, v115
    v_cvt_pk_f16_f32 v141, v118, v114
    v_mfma_f32_16x16x32_f16 v[36:39], v[128:131], v[92:95], 0
    v_cvt_pk_f16_f32 v142, v117, v113
    v_cvt_pk_f16_f32 v143, v116, v112
    ds_read_b128 v[92:95], v4 offset:448
    v_mfma_f32_16x16x32_f16 v[32:35], v[128:131], v[88:91], 0
    v_mfma_f32_16x16x32_f16 v[28:31], v[128:131], v[84:87], 0
    v_mfma_f32_16x16x32_f16 v[24:27], v[128:131], v[80:83], v[24:27]
    s_waitcnt lgkmcnt(3)
    v_mfma_f32_16x16x32_f16 v[96:99], v[144:147], v[40:43], 0
    v_mfma_f32_16x16x32_f16 v[100:103], v[144:147], v[44:47], 0
    v_mfma_f32_16x16x32_f16 v[104:107], v[148:151], v[40:43], 0
    v_mfma_f32_16x16x32_f16 v[108:111], v[148:151], v[44:47], 0
    ds_read_b128 v[148:151], v2 offset:1952
    v_mfma_f32_16x16x32_f16 v[112:115], v[144:147], v[48:51], 0
    ds_read_b128 v[144:147], v2 offset:1968
    s_waitcnt lgkmcnt(4)
    v_mfma_f32_16x16x32_f16 v[116:119], v[152:155], v[52:55], 0
    ds_read_b128 v[152:155], v2 offset:1984
    v_mfma_f32_16x16x32_f16 v[20:23], v[132:135], v[56:59], v[20:23]
    v_mfma_f32_16x16x32_f16 v[20:23], v[136:139], v[60:63], v[20:23]
    v_cvt_pk_f16_f32 v120, v97, v101
    v_cvt_pk_f16_f32 v122, v96, v100
    v_mfma_f32_16x16x32_f16 v[24:27], v[132:135], v[64:67], v[24:27]
    v_cvt_pk_f16_f32 v124, v99, v103
    v_cvt_pk_f16_f32 v126, v98, v102
    v_mfma_f32_16x16x32_f16 v[24:27], v[136:139], v[68:71], v[24:27]
    v_cvt_pk_f16_f32 v121, v105, v109
    v_cvt_pk_f16_f32 v123, v104, v108
    v_mfma_f32_16x16x32_f16 v[28:31], v[132:135], v[72:75], v[28:31]
    v_cvt_pk_f16_f32 v125, v107, v111
    v_cvt_pk_f16_f32 v127, v106, v110
    v_mfma_f32_16x16x32_f16 v[28:31], v[136:139], v[76:79], v[28:31]
    v_cvt_pk_f16_f32 v128, v119, v115
    v_cvt_pk_f16_f32 v129, v118, v114
    v_mfma_f32_16x16x32_f16 v[36:39], v[140:143], v[88:91], v[36:39]
    v_cvt_pk_f16_f32 v130, v117, v113
    v_cvt_pk_f16_f32 v131, v116, v112
    ds_read_b128 v[88:91], v4 offset:960
    v_mfma_f32_16x16x32_f16 v[32:35], v[140:143], v[84:87], v[32:35]
    v_mfma_f32_16x16x32_f16 v[28:31], v[140:143], v[80:83], v[28:31]
    s_waitcnt lgkmcnt(2)
    v_mfma_f32_16x16x32_f16 v[96:99], v[144:147], v[40:43], 0
    v_mfma_f32_16x16x32_f16 v[100:103], v[144:147], v[44:47], 0
    v_mfma_f32_16x16x32_f16 v[104:107], v[148:151], v[40:43], 0
    v_mfma_f32_16x16x32_f16 v[108:111], v[148:151], v[44:47], 0
    ds_read_b128 v[148:151], v2 offset:2464
    v_mfma_f32_16x16x32_f16 v[112:115], v[144:147], v[48:51], 0
    ds_read_b128 v[144:147], v2 offset:2480
    ds_read_b128 v[48:51], v4 offset:320
    s_waitcnt lgkmcnt(4)
    v_mfma_f32_16x16x32_f16 v[116:119], v[152:155], v[52:55], 0
    ds_read_b128 v[52:55], v4 offset:832
    ds_read_b128 v[152:155], v4 offset:256
    v_mfma_f32_16x16x32_f16 v[24:27], v[120:123], v[56:59], v[24:27]
    v_mfma_f32_16x16x32_f16 v[24:27], v[124:127], v[60:63], v[24:27]
    v_cvt_pk_f16_f32 v132, v97, v101
    v_cvt_pk_f16_f32 v134, v96, v100
    v_mfma_f32_16x16x32_f16 v[28:31], v[120:123], v[64:67], v[28:31]
    v_cvt_pk_f16_f32 v136, v99, v103
    v_cvt_pk_f16_f32 v138, v98, v102
    v_mfma_f32_16x16x32_f16 v[28:31], v[124:127], v[68:71], v[28:31]
    v_cvt_pk_f16_f32 v133, v105, v109
    v_cvt_pk_f16_f32 v135, v104, v108
    v_mfma_f32_16x16x32_f16 v[32:35], v[120:123], v[72:75], v[32:35]
    v_cvt_pk_f16_f32 v137, v107, v111
    v_cvt_pk_f16_f32 v139, v106, v110
    v_mfma_f32_16x16x32_f16 v[32:35], v[124:127], v[76:79], v[32:35]
    v_cvt_pk_f16_f32 v140, v119, v115
    v_cvt_pk_f16_f32 v141, v118, v114
    v_mfma_f32_16x16x32_f16 v[36:39], v[128:131], v[84:87], v[36:39]
    v_cvt_pk_f16_f32 v142, v117, v113
    v_cvt_pk_f16_f32 v143, v116, v112
    ds_read_b128 v[84:87], v4 offset:384
    ds_read_b128 v[112:115], v4 offset:768
    ds_read_b128 v[116:119], v4 offset:192
    v_mfma_f32_16x16x32_f16 v[32:35], v[128:131], v[80:83], v[32:35]
    ds_read_b128 v[128:131], v4 offset:64
    s_waitcnt lgkmcnt(7)
    v_mfma_f32_16x16x32_f16 v[96:99], v[144:147], v[40:43], 0
    v_mfma_f32_16x16x32_f16 v[100:103], v[144:147], v[44:47], 0
    ds_read_b128 v[144:147], v2 offset:2992
    v_mfma_f32_16x16x32_f16 v[104:107], v[148:151], v[40:43], 0
    v_mfma_f32_16x16x32_f16 v[108:111], v[148:151], v[44:47], 0
    ds_read_b128 v[148:151], v2 offset:2976
    v_mfma_f32_16x16x32_f16 v[28:31], v[132:135], v[56:59], v[28:31]
    v_mfma_f32_16x16x32_f16 v[28:31], v[136:139], v[60:63], v[28:31]
    v_mfma_f32_16x16x32_f16 v[32:35], v[132:135], v[64:67], v[32:35]
    v_mfma_f32_16x16x32_f16 v[32:35], v[136:139], v[68:71], v[32:35]
    v_cvt_pk_f16_f32 v120, v97, v101
    v_cvt_pk_f16_f32 v122, v96, v100
    v_mfma_f32_16x16x32_f16 v[36:39], v[132:135], v[72:75], v[36:39]
    v_cvt_pk_f16_f32 v124, v99, v103
    v_cvt_pk_f16_f32 v126, v98, v102
    ds_read_b128 v[72:75], v4 offset:128
    v_mfma_f32_16x16x32_f16 v[36:39], v[136:139], v[76:79], v[36:39]
    v_cvt_pk_f16_f32 v121, v105, v109
    v_cvt_pk_f16_f32 v123, v104, v108
    ds_read_b128 v[76:79], v4 offset:640
    v_mfma_f32_16x16x32_f16 v[36:39], v[140:143], v[80:83], v[36:39]
    v_cvt_pk_f16_f32 v125, v107, v111
    v_cvt_pk_f16_f32 v127, v106, v110
    ds_read_b128 v[80:83], v4 offset:704
    ds_read_b128 v[140:143], v4 offset:576
    s_waitcnt lgkmcnt(5)
    v_mfma_f32_16x16x32_f16 v[96:99], v[144:147], v[40:43], 0
    v_mfma_f32_16x16x32_f16 v[100:103], v[144:147], v[44:47], 0
    ds_read_b128 v[144:147], v2 offset:128
    s_waitcnt lgkmcnt(5)
    v_mfma_f32_16x16x32_f16 v[104:107], v[148:151], v[40:43], 0
    ds_read_b128 v[40:43], v2 offset:0
    v_mfma_f32_16x16x32_f16 v[108:111], v[148:151], v[44:47], 0
    ds_read_b128 v[44:47], v2 offset:64
    ds_read_b128 v[148:151], v2 offset:192
    v_mfma_f32_16x16x32_f16 v[32:35], v[120:123], v[56:59], v[32:35]
    v_mfma_f32_16x16x32_f16 v[32:35], v[124:127], v[60:63], v[32:35]
    v_mfma_f32_16x16x32_f16 v[36:39], v[120:123], v[64:67], v[36:39]
    ds_read_b128 v[64:67], v4 offset:0
    v_mfma_f32_16x16x32_f16 v[36:39], v[124:127], v[68:71], v[36:39]
    v_cvt_pk_f16_f32 v132, v97, v101
    v_cvt_pk_f16_f32 v133, v105, v109
    v_cvt_pk_f16_f32 v134, v96, v100
    v_cvt_pk_f16_f32 v135, v104, v108
    v_cvt_pk_f16_f32 v136, v99, v103
    v_cvt_pk_f16_f32 v137, v107, v111
    v_cvt_pk_f16_f32 v138, v98, v102
    v_cvt_pk_f16_f32 v139, v106, v110
    ds_read_b128 v[96:99], v2 offset:256
    ds_read_b128 v[100:103], v2 offset:320
    ds_read_b128 v[68:71], v4 offset:512
    v_mfma_f32_16x16x32_f16 v[36:39], v[132:135], v[56:59], v[36:39]
    ds_read_b128 v[104:107], v2 offset:384
    v_mfma_f32_16x16x32_f16 v[36:39], v[136:139], v[60:63], v[36:39]
    ds_read_b128 v[108:111], v2 offset:448
    s_waitcnt lgkmcnt(8)
    v_mfma_f32_16x16x32_f16 v[12:15], v[88:91], v[40:43], 0
    v_mfma_f32_16x16x32_f16 v[8:11], v[92:95], v[40:43], 0
    s_waitcnt lgkmcnt(7)
    v_mfma_f32_16x16x32_f16 v[12:15], v[156:159], v[44:47], v[12:15]
    v_mfma_f32_16x16x32_f16 v[8:11], v[84:87], v[44:47], v[8:11]
    ds_read_b128 v[40:43], v2 offset:512
    v_mfma_f32_16x16x32_f16 v[12:15], v[52:55], v[144:147], v[12:15]
    v_mfma_f32_16x16x32_f16 v[8:11], v[48:51], v[144:147], v[8:11]
    ds_read_b128 v[44:47], v2 offset:576
    s_waitcnt lgkmcnt(8)
    v_mfma_f32_16x16x32_f16 v[12:15], v[112:115], v[148:151], v[12:15]
    v_mfma_f32_16x16x32_f16 v[8:11], v[152:155], v[148:151], v[8:11]
    ds_read_b128 v[144:147], v2 offset:640
    s_waitcnt lgkmcnt(7)
    v_mfma_f32_16x16x32_f16 v[12:15], v[80:83], v[96:99], v[12:15]
    v_mfma_f32_16x16x32_f16 v[8:11], v[116:119], v[96:99], v[8:11]
    ds_read_b128 v[148:151], v2 offset:704
    s_waitcnt lgkmcnt(7)
    v_mfma_f32_16x16x32_f16 v[12:15], v[76:79], v[100:103], v[12:15]
    v_mfma_f32_16x16x32_f16 v[8:11], v[72:75], v[100:103], v[8:11]
    ds_read_b128 v[96:99], v2 offset:768
    s_waitcnt lgkmcnt(6)
    v_mfma_f32_16x16x32_f16 v[12:15], v[140:143], v[104:107], v[12:15]
    v_mfma_f32_16x16x32_f16 v[8:11], v[128:131], v[104:107], v[8:11]
    ds_read_b128 v[100:103], v2 offset:832
    s_waitcnt lgkmcnt(6)
    v_mfma_f32_16x16x32_f16 v[24:27], v[164:167], v[108:111], v[24:27]
    v_mfma_f32_16x16x32_f16 v[16:19], v[160:163], v[108:111], v[16:19]
    ds_read_b128 v[104:107], v2 offset:896
    v_mfma_f32_16x16x32_f16 v[12:15], v[68:71], v[108:111], v[12:15]
    v_mfma_f32_16x16x32_f16 v[8:11], v[64:67], v[108:111], v[8:11]
    ds_read_b128 v[108:111], v2 offset:960
    s_waitcnt lgkmcnt(7)
    v_mfma_f32_16x16x32_f16 v[16:19], v[88:91], v[40:43], v[16:19]
    v_mfma_f32_16x16x32_f16 v[12:15], v[92:95], v[40:43], v[12:15]
    s_waitcnt lgkmcnt(6)
    v_mfma_f32_16x16x32_f16 v[16:19], v[156:159], v[44:47], v[16:19]
    v_mfma_f32_16x16x32_f16 v[12:15], v[84:87], v[44:47], v[12:15]
    ds_read_b128 v[40:43], v2 offset:1024
    s_waitcnt lgkmcnt(6)
    v_mfma_f32_16x16x32_f16 v[16:19], v[52:55], v[144:147], v[16:19]
    v_mfma_f32_16x16x32_f16 v[12:15], v[48:51], v[144:147], v[12:15]
    v_mul_f32 v8, s11, v8
    v_mul_f32 v9, s11, v9
    ds_read_b128 v[44:47], v2 offset:1088
    s_waitcnt lgkmcnt(6)
    v_mfma_f32_16x16x32_f16 v[16:19], v[112:115], v[148:151], v[16:19]
    v_mul_f32 v10, s11, v10
    v_mul_f32 v11, s11, v11
    v_mfma_f32_16x16x32_f16 v[12:15], v[152:155], v[148:151], v[12:15]
    v_cvt_pk_bf16_f32 v8, v8, v9
    v_cvt_pk_bf16_f32 v9, v10, v11
    ds_read_b128 v[144:147], v2 offset:1152
    s_waitcnt lgkmcnt(6)
    v_mfma_f32_16x16x32_f16 v[16:19], v[80:83], v[96:99], v[16:19]
    v_min_u32 v8, -2, v8
    v_min_u32 v9, -2, v9
    v_mfma_f32_16x16x32_f16 v[12:15], v[116:119], v[96:99], v[12:15]
    v_mov_b32 v10, v8
    v_mov_b32 v11, v9
    ds_read_b128 v[148:151], v2 offset:1216
    s_waitcnt lgkmcnt(6)
    v_mfma_f32_16x16x32_f16 v[16:19], v[76:79], v[100:103], v[16:19]
    v_permlane16_swap_b32 v8, v10
    v_permlane16_swap_b32 v9, v11
    s_mov_b64 exec, s[20:21]
    buffer_store_dwordx4 v[8:11], v3, s[52:55], s15 offen offset:0 sc1
    s_mov_b64 exec, -1
    s_mov_b64 exec, 1
    ds_add_u32 v6, v7 offset:28
    s_mov_b64 exec, -1
    v_mfma_f32_16x16x32_f16 v[12:15], v[72:75], v[100:103], v[12:15]
    ds_read_b128 v[96:99], v2 offset:1280
    s_waitcnt lgkmcnt(7)
    v_mfma_f32_16x16x32_f16 v[16:19], v[140:143], v[104:107], v[16:19]
    v_mfma_f32_16x16x32_f16 v[12:15], v[128:131], v[104:107], v[12:15]
    ds_read_b128 v[100:103], v2 offset:1344
    s_waitcnt lgkmcnt(7)
    v_mfma_f32_16x16x32_f16 v[28:31], v[164:167], v[108:111], v[28:31]
    v_mfma_f32_16x16x32_f16 v[20:23], v[160:163], v[108:111], v[20:23]
    ds_read_b128 v[104:107], v2 offset:1408
    v_mfma_f32_16x16x32_f16 v[16:19], v[68:71], v[108:111], v[16:19]
    v_mfma_f32_16x16x32_f16 v[12:15], v[64:67], v[108:111], v[12:15]
    ds_read_b128 v[108:111], v2 offset:1472
    s_waitcnt lgkmcnt(8)
    v_mfma_f32_16x16x32_f16 v[20:23], v[88:91], v[40:43], v[20:23]
    v_mfma_f32_16x16x32_f16 v[16:19], v[92:95], v[40:43], v[16:19]
    s_waitcnt lgkmcnt(7)
    v_mfma_f32_16x16x32_f16 v[20:23], v[156:159], v[44:47], v[20:23]
    v_mfma_f32_16x16x32_f16 v[16:19], v[84:87], v[44:47], v[16:19]
    ds_read_b128 v[40:43], v2 offset:1536
    s_waitcnt lgkmcnt(7)
    v_mfma_f32_16x16x32_f16 v[20:23], v[52:55], v[144:147], v[20:23]
    v_mfma_f32_16x16x32_f16 v[16:19], v[48:51], v[144:147], v[16:19]
    v_mul_f32 v12, s11, v12
    v_mul_f32 v13, s11, v13
    ds_read_b128 v[44:47], v2 offset:1600
    s_waitcnt lgkmcnt(7)
    v_mfma_f32_16x16x32_f16 v[20:23], v[112:115], v[148:151], v[20:23]
    v_mul_f32 v14, s11, v14
    v_mul_f32 v15, s11, v15
    v_mfma_f32_16x16x32_f16 v[16:19], v[152:155], v[148:151], v[16:19]
    v_cvt_pk_bf16_f32 v12, v12, v13
    v_cvt_pk_bf16_f32 v13, v14, v15
    ds_read_b128 v[144:147], v2 offset:1664
    s_waitcnt lgkmcnt(6)
    v_mfma_f32_16x16x32_f16 v[20:23], v[80:83], v[96:99], v[20:23]
    v_min_u32 v12, -2, v12
    v_min_u32 v13, -2, v13
    v_mfma_f32_16x16x32_f16 v[16:19], v[116:119], v[96:99], v[16:19]
    v_mov_b32 v14, v12
    v_mov_b32 v15, v13
    ds_read_b128 v[148:151], v2 offset:1728
    s_waitcnt lgkmcnt(6)
    v_mfma_f32_16x16x32_f16 v[20:23], v[76:79], v[100:103], v[20:23]
    v_permlane16_swap_b32 v12, v14
    v_permlane16_swap_b32 v13, v15
    s_mov_b64 exec, s[20:21]
    buffer_store_dwordx4 v[12:15], v3, s[52:55], s15 offen offset:512 sc1
    s_mov_b64 exec, -1
    s_mov_b64 exec, 1
    ds_add_u32 v6, v7 offset:28
    s_mov_b64 exec, -1
    v_mfma_f32_16x16x32_f16 v[16:19], v[72:75], v[100:103], v[16:19]
    ds_read_b128 v[96:99], v2 offset:1792
    s_waitcnt lgkmcnt(7)
    v_mfma_f32_16x16x32_f16 v[20:23], v[140:143], v[104:107], v[20:23]
    v_mfma_f32_16x16x32_f16 v[16:19], v[128:131], v[104:107], v[16:19]
    ds_read_b128 v[100:103], v2 offset:1856
    s_waitcnt lgkmcnt(7)
    v_mfma_f32_16x16x32_f16 v[32:35], v[164:167], v[108:111], v[32:35]
    v_mfma_f32_16x16x32_f16 v[24:27], v[160:163], v[108:111], v[24:27]
    ds_read_b128 v[104:107], v2 offset:1920
    v_mfma_f32_16x16x32_f16 v[20:23], v[68:71], v[108:111], v[20:23]
    v_mfma_f32_16x16x32_f16 v[16:19], v[64:67], v[108:111], v[16:19]
    ds_read_b128 v[108:111], v2 offset:1984
    s_waitcnt lgkmcnt(8)
    v_mfma_f32_16x16x32_f16 v[24:27], v[88:91], v[40:43], v[24:27]
    v_mfma_f32_16x16x32_f16 v[20:23], v[92:95], v[40:43], v[20:23]
    s_waitcnt lgkmcnt(7)
    v_mfma_f32_16x16x32_f16 v[24:27], v[156:159], v[44:47], v[24:27]
    v_mfma_f32_16x16x32_f16 v[20:23], v[84:87], v[44:47], v[20:23]
    ds_read_b128 v[40:43], v2 offset:2048
    s_waitcnt lgkmcnt(7)
    v_mfma_f32_16x16x32_f16 v[24:27], v[52:55], v[144:147], v[24:27]
    v_mfma_f32_16x16x32_f16 v[20:23], v[48:51], v[144:147], v[20:23]
    v_mul_f32 v16, s11, v16
    v_mul_f32 v17, s11, v17
    ds_read_b128 v[44:47], v2 offset:2112
    s_waitcnt lgkmcnt(7)
    v_mfma_f32_16x16x32_f16 v[24:27], v[112:115], v[148:151], v[24:27]
    v_mul_f32 v18, s11, v18
    v_mul_f32 v19, s11, v19
    v_mfma_f32_16x16x32_f16 v[20:23], v[152:155], v[148:151], v[20:23]
    v_cvt_pk_bf16_f32 v16, v16, v17
    v_cvt_pk_bf16_f32 v17, v18, v19
    ds_read_b128 v[144:147], v2 offset:2176
    s_waitcnt lgkmcnt(6)
    v_mfma_f32_16x16x32_f16 v[24:27], v[80:83], v[96:99], v[24:27]
    v_min_u32 v16, -2, v16
    v_min_u32 v17, -2, v17
    v_mfma_f32_16x16x32_f16 v[20:23], v[116:119], v[96:99], v[20:23]
    v_mov_b32 v18, v16
    v_mov_b32 v19, v17
    ds_read_b128 v[148:151], v2 offset:2240
    s_waitcnt lgkmcnt(6)
    v_mfma_f32_16x16x32_f16 v[24:27], v[76:79], v[100:103], v[24:27]
    v_permlane16_swap_b32 v16, v18
    v_permlane16_swap_b32 v17, v19
    s_mov_b64 exec, s[20:21]
    buffer_store_dwordx4 v[16:19], v3, s[52:55], s15 offen offset:1024 sc1
    s_mov_b64 exec, -1
    s_mov_b64 exec, 1
    ds_add_u32 v6, v7 offset:28
    s_mov_b64 exec, -1
    v_mfma_f32_16x16x32_f16 v[20:23], v[72:75], v[100:103], v[20:23]
    ds_read_b128 v[96:99], v2 offset:2304
    s_waitcnt lgkmcnt(7)
    v_mfma_f32_16x16x32_f16 v[24:27], v[140:143], v[104:107], v[24:27]
    v_mfma_f32_16x16x32_f16 v[20:23], v[128:131], v[104:107], v[20:23]
    ds_read_b128 v[100:103], v2 offset:2368
    s_waitcnt lgkmcnt(7)
    v_mfma_f32_16x16x32_f16 v[36:39], v[164:167], v[108:111], v[36:39]
    v_mfma_f32_16x16x32_f16 v[28:31], v[160:163], v[108:111], v[28:31]
    ds_read_b128 v[104:107], v2 offset:2432
    v_mfma_f32_16x16x32_f16 v[24:27], v[68:71], v[108:111], v[24:27]
    v_mfma_f32_16x16x32_f16 v[20:23], v[64:67], v[108:111], v[20:23]
    ds_read_b128 v[108:111], v2 offset:2496
    s_waitcnt lgkmcnt(8)
    v_mfma_f32_16x16x32_f16 v[28:31], v[88:91], v[40:43], v[28:31]
    v_mfma_f32_16x16x32_f16 v[24:27], v[92:95], v[40:43], v[24:27]
    s_waitcnt lgkmcnt(7)
    v_mfma_f32_16x16x32_f16 v[28:31], v[156:159], v[44:47], v[28:31]
    ds_read_b128 v[40:43], v2 offset:2560
    v_mfma_f32_16x16x32_f16 v[24:27], v[84:87], v[44:47], v[24:27]
    s_waitcnt lgkmcnt(7)
    v_mfma_f32_16x16x32_f16 v[28:31], v[52:55], v[144:147], v[28:31]
    ds_read_b128 v[44:47], v2 offset:2624
    v_mfma_f32_16x16x32_f16 v[24:27], v[48:51], v[144:147], v[24:27]
    v_mul_f32 v20, s11, v20
    v_mul_f32 v21, s11, v21
    s_waitcnt lgkmcnt(7)
    v_mfma_f32_16x16x32_f16 v[28:31], v[112:115], v[148:151], v[28:31]
    v_mul_f32 v22, s11, v22
    v_mul_f32 v23, s11, v23
    ds_read_b128 v[144:147], v2 offset:2688
    v_mfma_f32_16x16x32_f16 v[24:27], v[152:155], v[148:151], v[24:27]
    v_cvt_pk_bf16_f32 v20, v20, v21
    v_cvt_pk_bf16_f32 v21, v22, v23
    s_waitcnt lgkmcnt(6)
    v_mfma_f32_16x16x32_f16 v[28:31], v[80:83], v[96:99], v[28:31]
    v_min_u32 v20, -2, v20
    v_min_u32 v21, -2, v21
    ds_read_b128 v[148:151], v2 offset:2752
    v_mfma_f32_16x16x32_f16 v[24:27], v[116:119], v[96:99], v[24:27]
    v_mov_b32 v22, v20
    v_mov_b32 v23, v21
    s_waitcnt lgkmcnt(6)
    v_mfma_f32_16x16x32_f16 v[28:31], v[76:79], v[100:103], v[28:31]
    v_permlane16_swap_b32 v20, v22
    v_permlane16_swap_b32 v21, v23
    s_mov_b64 exec, s[20:21]
    buffer_store_dwordx4 v[20:23], v3, s[52:55], s15 offen offset:1536 sc1
    s_mov_b64 exec, -1
    s_mov_b64 exec, 1
    ds_add_u32 v6, v7 offset:28
    s_mov_b64 exec, -1
    ds_read_b128 v[96:99], v2 offset:2816
    v_mfma_f32_16x16x32_f16 v[24:27], v[72:75], v[100:103], v[24:27]
    s_waitcnt lgkmcnt(7)
    v_mfma_f32_16x16x32_f16 v[28:31], v[140:143], v[104:107], v[28:31]
    ds_read_b128 v[100:103], v2 offset:2880
    v_mfma_f32_16x16x32_f16 v[24:27], v[128:131], v[104:107], v[24:27]
    s_waitcnt lgkmcnt(7)
    v_mfma_f32_16x16x32_f16 v[32:35], v[160:163], v[108:111], v[32:35]
    ds_read_b128 v[104:107], v2 offset:2944
    v_mfma_f32_16x16x32_f16 v[28:31], v[68:71], v[108:111], v[28:31]
    v_mfma_f32_16x16x32_f16 v[24:27], v[64:67], v[108:111], v[24:27]
    ds_read_b128 v[108:111], v2 offset:3008
    s_waitcnt lgkmcnt(8)
    v_mfma_f32_16x16x32_f16 v[32:35], v[88:91], v[40:43], v[32:35]
    v_mfma_f32_16x16x32_f16 v[28:31], v[92:95], v[40:43], v[28:31]
    s_waitcnt lgkmcnt(7)
    v_mfma_f32_16x16x32_f16 v[32:35], v[156:159], v[44:47], v[32:35]
    ds_read_b128 v[40:43], v2 offset:3072
    v_mfma_f32_16x16x32_f16 v[28:31], v[84:87], v[44:47], v[28:31]
    s_waitcnt lgkmcnt(7)
    v_mfma_f32_16x16x32_f16 v[32:35], v[52:55], v[144:147], v[32:35]
    ds_read_b128 v[44:47], v2 offset:3136
    v_mfma_f32_16x16x32_f16 v[28:31], v[48:51], v[144:147], v[28:31]
    v_mul_f32 v24, s11, v24
    v_mul_f32 v25, s11, v25
    s_waitcnt lgkmcnt(7)
    v_mfma_f32_16x16x32_f16 v[32:35], v[112:115], v[148:151], v[32:35]
    v_mul_f32 v26, s11, v26
    v_mul_f32 v27, s11, v27
    ds_read_b128 v[144:147], v2 offset:3200
    v_mfma_f32_16x16x32_f16 v[28:31], v[152:155], v[148:151], v[28:31]
    v_cvt_pk_bf16_f32 v24, v24, v25
    v_cvt_pk_bf16_f32 v25, v26, v27
    s_waitcnt lgkmcnt(6)
    v_mfma_f32_16x16x32_f16 v[32:35], v[80:83], v[96:99], v[32:35]
    v_min_u32 v24, -2, v24
    v_min_u32 v25, -2, v25
    ds_read_b128 v[148:151], v2 offset:3264
    v_mfma_f32_16x16x32_f16 v[28:31], v[116:119], v[96:99], v[28:31]
    v_mov_b32 v26, v24
    v_mov_b32 v27, v25
    s_waitcnt lgkmcnt(6)
    v_mfma_f32_16x16x32_f16 v[32:35], v[76:79], v[100:103], v[32:35]
    v_permlane16_swap_b32 v24, v26
    v_permlane16_swap_b32 v25, v27
    s_mov_b64 exec, s[20:21]
    buffer_store_dwordx4 v[24:27], v3, s[52:55], s15 offen offset:2048 sc1
    s_mov_b64 exec, -1
    s_mov_b64 exec, 1
    ds_add_u32 v6, v7 offset:28
    s_mov_b64 exec, -1
    ds_read_b128 v[96:99], v2 offset:3328
    v_mfma_f32_16x16x32_f16 v[28:31], v[72:75], v[100:103], v[28:31]
    s_waitcnt lgkmcnt(7)
    v_mfma_f32_16x16x32_f16 v[32:35], v[140:143], v[104:107], v[32:35]
    ds_read_b128 v[100:103], v2 offset:3392
    v_mfma_f32_16x16x32_f16 v[28:31], v[128:131], v[104:107], v[28:31]
    s_waitcnt lgkmcnt(7)
    v_mfma_f32_16x16x32_f16 v[36:39], v[160:163], v[108:111], v[36:39]
    ds_read_b128 v[104:107], v2 offset:3456
    v_mfma_f32_16x16x32_f16 v[32:35], v[68:71], v[108:111], v[32:35]
    v_mfma_f32_16x16x32_f16 v[28:31], v[64:67], v[108:111], v[28:31]
    ds_read_b128 v[108:111], v2 offset:3520
    s_waitcnt lgkmcnt(8)
    v_mfma_f32_16x16x32_f16 v[36:39], v[88:91], v[40:43], v[36:39]
    v_mfma_f32_16x16x32_f16 v[32:35], v[92:95], v[40:43], v[32:35]
    ds_read_b128 v[40:43], v2 offset:3584
    s_waitcnt lgkmcnt(8)
    v_mfma_f32_16x16x32_f16 v[36:39], v[156:159], v[44:47], v[36:39]
    v_mfma_f32_16x16x32_f16 v[32:35], v[84:87], v[44:47], v[32:35]
    ds_read_b128 v[44:47], v2 offset:3648
    s_waitcnt lgkmcnt(8)
    v_mfma_f32_16x16x32_f16 v[36:39], v[52:55], v[144:147], v[36:39]
    v_mfma_f32_16x16x32_f16 v[32:35], v[48:51], v[144:147], v[32:35]
    v_mul_f32 v28, s11, v28
    v_mul_f32 v29, s11, v29
    ds_read_b128 v[144:147], v2 offset:3712
    s_waitcnt lgkmcnt(8)
    v_mfma_f32_16x16x32_f16 v[36:39], v[112:115], v[148:151], v[36:39]
    v_mul_f32 v30, s11, v30
    v_mul_f32 v31, s11, v31
    v_mfma_f32_16x16x32_f16 v[32:35], v[152:155], v[148:151], v[32:35]
    v_cvt_pk_bf16_f32 v28, v28, v29
    v_cvt_pk_bf16_f32 v29, v30, v31
    ds_read_b128 v[148:151], v2 offset:3776
    s_waitcnt lgkmcnt(7)
    v_mfma_f32_16x16x32_f16 v[36:39], v[80:83], v[96:99], v[36:39]
    v_min_u32 v28, -2, v28
    v_min_u32 v29, -2, v29
    v_mfma_f32_16x16x32_f16 v[32:35], v[116:119], v[96:99], v[32:35]
    v_mov_b32 v30, v28
    v_mov_b32 v31, v29
    ds_read_b128 v[96:99], v2 offset:3840
    s_waitcnt lgkmcnt(7)
    v_mfma_f32_16x16x32_f16 v[36:39], v[76:79], v[100:103], v[36:39]
    v_permlane16_swap_b32 v28, v30
    v_permlane16_swap_b32 v29, v31
    s_mov_b64 exec, s[20:21]
    buffer_store_dwordx4 v[28:31], v3, s[52:55], s15 offen offset:2560 sc1
    s_mov_b64 exec, -1
    s_mov_b64 exec, 1
    ds_add_u32 v6, v7 offset:28
    s_mov_b64 exec, -1
    v_mfma_f32_16x16x32_f16 v[32:35], v[72:75], v[100:103], v[32:35]
    ds_read_b128 v[100:103], v2 offset:3904
    s_waitcnt lgkmcnt(8)
    v_mfma_f32_16x16x32_f16 v[36:39], v[140:143], v[104:107], v[36:39]
    v_mfma_f32_16x16x32_f16 v[32:35], v[128:131], v[104:107], v[32:35]
    ds_read_b128 v[104:107], v2 offset:3968
    s_waitcnt lgkmcnt(8)
    v_mfma_f32_16x16x32_f16 v[36:39], v[68:71], v[108:111], v[36:39]
    v_mfma_f32_16x16x32_f16 v[32:35], v[64:67], v[108:111], v[32:35]
    ds_read_b128 v[108:111], v2 offset:4032
    s_waitcnt lgkmcnt(8)
    v_mfma_f32_16x16x32_f16 v[36:39], v[92:95], v[40:43], v[36:39]
    s_waitcnt lgkmcnt(7)
    v_mfma_f32_16x16x32_f16 v[36:39], v[84:87], v[44:47], v[36:39]
    s_waitcnt lgkmcnt(6)
    v_mfma_f32_16x16x32_f16 v[36:39], v[48:51], v[144:147], v[36:39]
    s_waitcnt lgkmcnt(5)
    v_mfma_f32_16x16x32_f16 v[36:39], v[152:155], v[148:151], v[36:39]
    s_waitcnt lgkmcnt(4)
    v_mfma_f32_16x16x32_f16 v[36:39], v[116:119], v[96:99], v[36:39]
    s_waitcnt lgkmcnt(2)
    v_mfma_f32_16x16x32_f16 v[36:39], v[72:75], v[100:103], v[36:39]
    v_mul_f32 v32, s11, v32
    v_mul_f32 v33, s11, v33
    s_waitcnt lgkmcnt(1)
    v_mfma_f32_16x16x32_f16 v[36:39], v[128:131], v[104:107], v[36:39]
    v_mul_f32 v34, s11, v34
    v_mul_f32 v35, s11, v35
    s_waitcnt lgkmcnt(0)
    v_mfma_f32_16x16x32_f16 v[36:39], v[64:67], v[108:111], v[36:39]
    v_cvt_pk_bf16_f32 v32, v32, v33
    v_cvt_pk_bf16_f32 v33, v34, v35
    v_min_u32 v32, -2, v32
    v_min_u32 v33, -2, v33
    v_mov_b32 v34, v32
    v_mov_b32 v35, v33
    s_nop 0
    v_permlane16_swap_b32 v32, v34
    v_permlane16_swap_b32 v33, v35
    s_mov_b64 exec, s[20:21]
    buffer_store_dwordx4 v[32:35], v3, s[52:55], s15 offen offset:3072 sc1
    s_mov_b64 exec, -1
    s_mov_b64 exec, 1
    ds_add_u32 v6, v7 offset:28
    s_mov_b64 exec, -1
    v_mul_f32 v36, s11, v36
    v_mul_f32 v37, s11, v37
    v_mul_f32 v38, s11, v38
    v_mul_f32 v39, s11, v39
    v_cvt_pk_bf16_f32 v36, v36, v37
    v_cvt_pk_bf16_f32 v37, v38, v39
    v_min_u32 v36, -2, v36
    v_min_u32 v37, -2, v37
    v_mov_b32 v38, v36
    v_mov_b32 v39, v37
    s_nop 0
    v_permlane16_swap_b32 v36, v38
    v_permlane16_swap_b32 v37, v39
    s_mov_b64 exec, s[20:21]
    buffer_store_dwordx4 v[36:39], v3, s[52:55], s15 offen offset:3584 sc1
    s_mov_b64 exec, -1
    s_mov_b64 exec, 1
    ds_add_u32 v6, v7 offset:28
    s_mov_b64 exec, -1
    s_endpgm
k2_G:
    s_mov_b32 s48, s16
    s_and_b32 s49, s17, 0xffff
    s_mov_b32 s50, 0x400000
    s_mov_b32 s51, 0x20000
    s_mov_b32 s56, s28
    s_and_b32 s57, s29, 0xffff
    s_mov_b32 s58, 0x800
    s_mov_b32 s59, 0x20000
    s_mov_b32 s60, s34
    s_and_b32 s61, s35, 0xffff
    s_mov_b32 s62, 0x700000
    s_mov_b32 s63, 0x20000
    s_mov_b32 s64, s36
    s_and_b32 s65, s37, 0xffff
    s_mov_b32 s66, 0x700000
    s_mov_b32 s67, 0x20000
    s_mov_b32 s68, s38
    s_and_b32 s69, s39, 0xffff
    s_mov_b32 s70, 0x700000
    s_mov_b32 s71, 0x20000
    s_mov_b32 s72, s40
    s_and_b32 s73, s41, 0xffff
    s_mov_b32 s74, 0x400000
    s_mov_b32 s75, 0x20000
    s_sub_u32 s3, s3, 4
    v_mov_b32 v6, 143040
    v_mov_b32 v7, 1
    v_mov_b32 v12, 0
    v_mov_b32 v13, 0
    v_mov_b32 v14, 0
    v_mov_b32 v15, 0
    v_lshlrev_b32 v16, 4, v1
    v_add_u32 v17, 142464, v16
    s_mov_b32 exec_hi, 15
    ds_write_b128 v17, v[12:15]
    s_mov_b64 exec, -1
    s_waitcnt lgkmcnt(0)
    s_barrier
    v_mov_b32 v44, 0
    s_cmp_lg_u32 s3, 3
    s_cbranch_scc1 k2_g_noep
    s_cmp_lg_u32 s2, 255
    s_cbranch_scc1 k2_g_noep
    s_mov_b32 s76, s42
    s_and_b32 s77, s43, 0xffff
    s_mov_b32 s78, 0x100
    s_mov_b32 s79, 0x20000
    v_mov_b32 v45, 0
    s_mov_b32 s25, 0x5fc000
    buffer_load_dword v44, v45, s[52:55], s25 offen sc1
    s_mov_b32 s26, 0x9e3779b1
    s_waitcnt vmcnt(0)
    v_mul_lo_u32 v44, v44, s26
    v_add_u32 v44, 0x7f4a7c15, v44
    v_max_u32 v44, 1, v44
    s_mov_b64 exec, 1
    buffer_store_dword v44, v45, s[76:79], 0 offen sc1
    buffer_store_dword v44, v45, s[52:55], s25 offen sc1
    s_mov_b64 exec, -1
k2_g_noep:
    s_nop 0
    v_mov_b32 v40, -1
    v_mov_b32 v41, -1
    v_mov_b32 v42, -1
    v_mov_b32 v43, -1
    s_lshl_b32 s9, s2, 9
    s_lshl_b32 s10, s3, 7
    s_add_u32 s9, s9, s10
    s_add_u32 s9, s9, 0x5c0000
    s_mov_b64 exec, 0xff
    buffer_store_dwordx4 v[40:43], v16, s[52:55], s9 offen sc1
    s_mov_b64 exec, -1
    s_lshl_b32 s9, s2, 12
    s_lshl_b32 s10, s3, 10
    s_add_u32 s9, s9, s10
    s_add_u32 s9, s9, 0x600000
    buffer_store_dwordx4 v[40:43], v16, s[52:55], s9 offen sc1
    s_lshl_b32 s9, s6, 2
    s_add_u32 s9, s9, s3
    s_lshl_b32 s9, s9, 12
    buffer_store_dwordx4 v[40:43], v16, s[52:55], s9 offen offset:0 sc1
    buffer_store_dwordx4 v[40:43], v16, s[52:55], s9 offen offset:1024 sc1
    buffer_store_dwordx4 v[40:43], v16, s[52:55], s9 offen offset:2048 sc1
    buffer_store_dwordx4 v[40:43], v16, s[52:55], s9 offen offset:3072 sc1
    v_lshrrev_b32 v2, 3, v1
    v_and_b32 v4, 7, v1
    s_lshl_b32 s9, s8, 8
    s_lshl_b32 s10, s3, 6
    s_add_u32 s9, s9, s10
    v_add_u32 v3, s9, v2
    v_mul_u32_u24 v3, 7168, v3
    v_lshl_add_u32 v3, v4, 4, v3
    s_lshl_b32 s11, s7, 7
    s_cmp_ge_u32 s5, 28
    s_nop 2
    s_cbranch_scc1 k2_g_pt
    buffer_load_dwordx4 v[96:99], v3, s[60:63], s11 offen nt
    buffer_load_dwordx4 v[100:103], v3, s[64:67], s11 offen nt
    s_add_u32 s11, s11, 57344
    buffer_load_dwordx4 v[104:107], v3, s[60:63], s11 offen nt
    buffer_load_dwordx4 v[108:111], v3, s[64:67], s11 offen nt
    s_add_u32 s11, s11, 57344
    buffer_load_dwordx4 v[112:115], v3, s[60:63], s11 offen nt
    buffer_load_dwordx4 v[116:119], v3, s[64:67], s11 offen nt
    s_add_u32 s11, s11, 57344
    buffer_load_dwordx4 v[120:123], v3, s[60:63], s11 offen nt
    buffer_load_dwordx4 v[124:127], v3, s[64:67], s11 offen nt
    s_add_u32 s11, s11, 57344
k2_g_pt:
    s_mov_b32 s14, 0x3412
    s_lshl_b32 s15, s3, 2
    s_lshr_b32 s14, s14, s15
    s_and_b32 s14, s14, 15
    s_cmp_eq_u32 s3, 1
    s_cselect_b32 s15, -4, -8
    s_add_u32 s15, s15, s14
    s_lshl_b32 s14, s14, 1
    v_lshrrev_b32 v18, 4, v1
    v_lshlrev_b32 v18, 3, v18
    v_and_b32 v19, 15, v1
    v_sub_u32 v18, v18, v19
    v_add_u32 v18, s15, v18
    v_mov_b32 v20, 0x3c00
    v_mov_b32 v21, 0x3c000000
    v_add_u32 v22, 0, v18
    v_cmp_ge_u32 vcc, s14, v22
    s_nop 1
    v_cndmask_b32 v24, 0, v20, vcc
    v_add_u32 v22, 1, v18
    v_cmp_ge_u32 vcc, s14, v22
    s_nop 1
    v_cndmask_b32 v25, 0, v21, vcc
    v_add_u32 v22, 2, v18
    v_cmp_ge_u32 vcc, s14, v22
    s_nop 1
    v_cndmask_b32 v26, 0, v20, vcc
    v_add_u32 v22, 3, v18
    v_cmp_ge_u32 vcc, s14, v22
    s_nop 1
    v_cndmask_b32 v27, 0, v21, vcc
    v_add_u32 v22, 4, v18
    v_cmp_ge_u32 vcc, s14, v22
    s_nop 1
    v_cndmask_b32 v28, 0, v20, vcc
    v_add_u32 v22, 5, v18
    v_cmp_ge_u32 vcc, s14, v22
    s_nop 1
    v_cndmask_b32 v29, 0, v21, vcc
    v_add_u32 v22, 6, v18
    v_cmp_ge_u32 vcc, s14, v22
    s_nop 1
    v_cndmask_b32 v30, 0, v20, vcc
    v_add_u32 v22, 7, v18
    v_cmp_ge_u32 vcc, s14, v22
    s_nop 1
    v_cndmask_b32 v31, 0, v21, vcc
    v_or_b32 v12, v24, v25
    v_or_b32 v13, v26, v27
    v_or_b32 v14, v28, v29
    v_or_b32 v15, v30, v31
    s_lshl_b32 s14, s3, 10
    s_add_u32 s14, s14, 137344
    v_add_u32 v17, s14, v16
    ds_write_b128 v17, v[12:15]
    s_waitcnt lgkmcnt(0)
    s_mov_b64 exec, 1
    ds_add_u32 v6, v7 offset:48
    s_mov_b64 exec, -1
    s_cmp_ge_u32 s5, 28
    s_cbranch_scc1 k2_R
    s_lshl_b32 s16, s7, 6
    s_lshl_b32 s13, s8, 4
    s_add_u32 s16, s16, s13
    s_lshl_b32 s16, s16, 11
    s_lshl_b32 s13, s3, 9
    s_add_u32 s16, s16, s13
    v_lshrrev_b32 v8, 5, v1
    v_and_b32 v9, 31, v1
    v_lshlrev_b32 v10, 11, v8
    v_lshl_add_u32 v10, v9, 4, v10
    v_mul_u32_u24 v11, 544, v8
    v_lshl_add_u32 v11, v9, 4, v11
    s_mul_i32 s13, s3, 8704
    s_add_u32 s13, s13, 53376
    v_add_u32 v11, s13, v11
    v_and_b32 v5, 2, v2
    v_xor_b32 v4, v4, v5
    v_lshlrev_b32 v5, 7, v2
    v_lshl_add_u32 v4, v4, 4, v5
    s_lshl_b32 s12, s3, 13
    s_add_u32 s12, s12, 53376
    v_add_u32 v4, s12, v4
    v_xor_b32 v5, 64, v4
    s_waitcnt vmcnt(8)
    s_waitcnt lgkmcnt(0)
    s_mov_b64 exec, 1
    ds_add_u32 v6, v7 offset:36
    s_mov_b64 exec, -1
    s_waitcnt vmcnt(2)
    buffer_load_dwordx4 v[128:131], v3, s[60:63], s11 offen nt
    buffer_load_dwordx4 v[132:135], v3, s[64:67], s11 offen nt
    s_add_u32 s11, s11, 57344
    s_waitcnt vmcnt(2)
    buffer_load_dwordx4 v[136:139], v3, s[60:63], s11 offen nt
    buffer_load_dwordx4 v[140:143], v3, s[64:67], s11 offen nt
    s_add_u32 s11, s11, 57344
    s_waitcnt vmcnt(2)
    buffer_load_dwordx4 v[144:147], v3, s[60:63], s11 offen nt
    buffer_load_dwordx4 v[148:151], v3, s[64:67], s11 offen nt
    s_add_u32 s11, s11, 57344
    s_waitcnt vmcnt(2)
    buffer_load_dwordx4 v[152:155], v3, s[60:63], s11 offen nt
    buffer_load_dwordx4 v[156:159], v3, s[64:67], s11 offen nt
    s_add_u32 s11, s11, 57344
    s_waitcnt vmcnt(2)
    buffer_load_dwordx4 v[64:67], v10, s[68:71], s16 offen nt
    s_add_u32 s16, s16, 4096
    buffer_load_dwordx4 v[68:71], v10, s[68:71], s16 offen nt
    s_add_u32 s16, s16, 4096
    s_waitcnt vmcnt(2)
    buffer_load_dwordx4 v[72:75], v10, s[68:71], s16 offen nt
    s_add_u32 s16, s16, 4096
    buffer_load_dwordx4 v[76:79], v10, s[68:71], s16 offen nt
    s_add_u32 s16, s16, 4096
    s_waitcnt vmcnt(2)
    buffer_load_dwordx4 v[80:83], v10, s[68:71], s16 offen nt
    s_add_u32 s16, s16, 4096
    buffer_load_dwordx4 v[84:87], v10, s[68:71], s16 offen nt
    s_add_u32 s16, s16, 4096
    s_waitcnt vmcnt(2)
    buffer_load_dwordx4 v[88:91], v10, s[68:71], s16 offen nt
    s_add_u32 s16, s16, 4096
    buffer_load_dwordx4 v[92:95], v10, s[68:71], s16 offen nt
    v_lshrrev_b32 v16, 4, v1
    v_bfe_u32 v17, v1, 2, 2
    v_and_b32 v18, 3, v1
    v_lshrrev_b32 v19, 1, v17
    v_and_b32 v20, 1, v16
    v_lshl_or_b32 v19, v20, 1, v19
    v_xor_b32 v19, s3, v19
    v_lshl_add_u32 v20, v16, 3, v17
    v_lshlrev_b32 v20, 7, v20
    v_lshl_add_u32 v20, v19, 5, v20
    v_lshl_add_u32 v20, v18, 3, v20
    v_add_u32 v20, 53376, v20
    v_lshlrev_b32 v21, 4, v16
    v_add_u32 v22, 141952, v21
    v_add_u32 v23, 142464, v21
    v_cmp_eq_u32 vcc, 0, v17
    s_nop 1
    v_cndmask_b32 v24, v23, v22, vcc
    v_cmp_eq_u32 vcc, 1, v17
    s_nop 1
    v_cndmask_b32 v25, v23, v22, vcc
    v_lshl_add_u32 v26, v16, 2, v17
    v_mul_u32_u24 v26, 544, v26
    v_lshl_add_u32 v26, v18, 3, v26
    v_add_u32 v26, s13, v26
    v_lshlrev_b32 v21, 3, v16
    v_add_u32 v22, 142976, v21
    v_add_u32 v23, 143008, v21
    v_cmp_eq_u32 vcc, 0, v17
    s_nop 1
    v_cndmask_b32 v28, v23, v22, vcc
    v_cmp_eq_u32 vcc, 1, v17
    s_nop 1
    v_cndmask_b32 v29, v23, v22, vcc
    v_cmp_eq_u32 vcc, 2, v17
    s_nop 1
    v_cndmask_b32 v30, v23, v22, vcc
    v_cmp_eq_u32 vcc, 3, v17
    s_nop 1
    v_cndmask_b32 v31, v23, v22, vcc
    s_lshl_b32 s12, s7, 11
    s_add_u32 s12, s12, 0x5c0000
    s_lshl_b32 s15, s8, 9
    s_add_u32 s15, s15, s12
    s_lshl_b32 s14, s3, 7
    s_add_u32 s15, s15, s14
    v_lshlrev_b32 v27, 2, v1
    s_nop 4
k2_gkg:
    ds_read_b32 v8, v6 offset:44
    s_waitcnt lgkmcnt(0)
    v_readfirstlane_b32 s14, v8
    s_cmp_ge_u32 s14, 4
    s_cbranch_scc1 k2_gkg_done
    s_sleep 1
    s_branch k2_gkg
k2_gkg_done:
    s_nop 0
    s_waitcnt vmcnt(8)
    ds_write_b128 v4, v[96:99] offset:0
    ds_write_b128 v4, v[100:103] offset:32768
    ds_write_b128 v5, v[104:107] offset:1024
    ds_write_b128 v5, v[108:111] offset:33792
    ds_write_b128 v4, v[112:115] offset:2048
    ds_write_b128 v4, v[116:119] offset:34816
    ds_write_b128 v5, v[120:123] offset:3072
    ds_write_b128 v5, v[124:127] offset:35840
    ds_write_b128 v4, v[128:131] offset:4096
    ds_write_b128 v4, v[132:135] offset:36864
    ds_write_b128 v5, v[136:139] offset:5120
    ds_write_b128 v5, v[140:143] offset:37888
    ds_write_b128 v4, v[144:147] offset:6144
    ds_write_b128 v4, v[148:151] offset:38912
    ds_write_b128 v5, v[152:155] offset:7168
    ds_write_b128 v5, v[156:159] offset:39936
    s_waitcnt lgkmcnt(0)
    s_mov_b64 exec, 1
    ds_add_u32 v6, v7 offset:8
    s_mov_b64 exec, -1
k2_gw:
    ds_read_b32 v8, v6 offset:8
    s_waitcnt lgkmcnt(0)
    v_readfirstlane_b32 s14, v8
    s_cmp_ge_u32 s14, 4
    s_cbranch_scc1 k2_gw_done
    s_sleep 1
    s_branch k2_gw
k2_gw_done:
    s_nop 0
    ds_read_b64_tr_b16 v[96:97], v20 offset:0
    ds_read_b64_tr_b16 v[98:99], v20 offset:512
    ds_read_b64_tr_b16 v[100:101], v20 offset:32768
    ds_read_b64_tr_b16 v[102:103], v20 offset:33280
    ds_read_b64_tr_b16 v[104:105], v20 offset:4096
    ds_read_b64_tr_b16 v[106:107], v20 offset:4608
    ds_read_b64_tr_b16 v[108:109], v20 offset:36864
    ds_read_b64_tr_b16 v[110:111], v20 offset:37376
    ds_read_b64_tr_b16 v[112:113], v20 offset:8192
    ds_read_b64_tr_b16 v[114:115], v20 offset:8704
    ds_read_b64_tr_b16 v[116:117], v20 offset:40960
    ds_read_b64_tr_b16 v[118:119], v20 offset:41472
    ds_read_b64_tr_b16 v[120:121], v20 offset:12288
    ds_read_b64_tr_b16 v[122:123], v20 offset:12800
    ds_read_b64_tr_b16 v[124:125], v20 offset:45056
    ds_read_b64_tr_b16 v[126:127], v20 offset:45568
    ds_read_b64_tr_b16 v[128:129], v20 offset:16384
    ds_read_b64_tr_b16 v[130:131], v20 offset:16896
    ds_read_b64_tr_b16 v[132:133], v20 offset:49152
    ds_read_b64_tr_b16 v[134:135], v20 offset:49664
    ds_read_b64_tr_b16 v[136:137], v20 offset:20480
    ds_read_b64_tr_b16 v[138:139], v20 offset:20992
    ds_read_b64_tr_b16 v[140:141], v20 offset:53248
    ds_read_b64_tr_b16 v[142:143], v20 offset:53760
    ds_read_b64_tr_b16 v[144:145], v20 offset:24576
    ds_read_b64_tr_b16 v[146:147], v20 offset:25088
    ds_read_b64_tr_b16 v[148:149], v20 offset:57344
    ds_read_b64_tr_b16 v[150:151], v20 offset:57856
    ds_read_b64_tr_b16 v[152:153], v20 offset:28672
    ds_read_b64_tr_b16 v[154:155], v20 offset:29184
    ds_read_b64_tr_b16 v[156:157], v20 offset:61440
    ds_read_b64_tr_b16 v[158:159], v20 offset:61952
    s_waitcnt lgkmcnt(0)
    s_mov_b64 exec, 1
    ds_add_u32 v6, v7 offset:12
    s_mov_b64 exec, -1
k2_gc:
    ds_read_b32 v8, v6 offset:12
    s_waitcnt lgkmcnt(0)
    v_readfirstlane_b32 s14, v8
    s_cmp_ge_u32 s14, 4
    s_cbranch_scc1 k2_gc_done
    s_sleep 1
    s_branch k2_gc
k2_gc_done:
    s_nop 0
    s_waitcnt vmcnt(0)
    ds_write_b128 v11, v[64:67] offset:0
    ds_write_b128 v11, v[68:71] offset:1088
    ds_write_b128 v11, v[72:75] offset:2176
    ds_write_b128 v11, v[76:79] offset:3264
    ds_write_b128 v11, v[80:83] offset:4352
    ds_write_b128 v11, v[84:87] offset:5440
    ds_write_b128 v11, v[88:91] offset:6528
    ds_write_b128 v11, v[92:95] offset:7616
    s_waitcnt lgkmcnt(0)
    ds_read_b64_tr_b16 v[64:65], v26 offset:0
    ds_read_b64_tr_b16 v[66:67], v26 offset:32
    ds_read_b64_tr_b16 v[68:69], v26 offset:64
    ds_read_b64_tr_b16 v[70:71], v26 offset:96
    ds_read_b64_tr_b16 v[72:73], v26 offset:128
    ds_read_b64_tr_b16 v[74:75], v26 offset:160
    ds_read_b64_tr_b16 v[76:77], v26 offset:192
    ds_read_b64_tr_b16 v[78:79], v26 offset:224
    ds_read_b64_tr_b16 v[80:81], v26 offset:256
    ds_read_b64_tr_b16 v[82:83], v26 offset:288
    ds_read_b64_tr_b16 v[84:85], v26 offset:320
    ds_read_b64_tr_b16 v[86:87], v26 offset:352
    ds_read_b64_tr_b16 v[88:89], v26 offset:384
    ds_read_b64_tr_b16 v[90:91], v26 offset:416
    ds_read_b64_tr_b16 v[92:93], v26 offset:448
    ds_read_b64_tr_b16 v[94:95], v26 offset:480
k2_gx:
    ds_read_b32 v8, v6 offset:4
    s_waitcnt lgkmcnt(0)
    v_readfirstlane_b32 s14, v8
    s_cmp_ge_u32 s14, 1
    s_cbranch_scc1 k2_gx_done
    s_sleep 1
    s_branch k2_gx
k2_gx_done:
    s_nop 0
    ds_read_b128 v[32:35], v24 offset:0
    ds_read_b128 v[36:39], v24 offset:64
    ds_read_b128 v[40:43], v24 offset:128
    ds_read_b128 v[44:47], v24 offset:192
    ds_read_b128 v[48:51], v24 offset:256
    ds_read_b128 v[52:55], v24 offset:320
    ds_read_b128 v[56:59], v24 offset:384
    ds_read_b128 v[60:63], v24 offset:448
    s_waitcnt lgkmcnt(7)
    v_mfma_f32_16x16x32_bf16 v[12:15], v[32:35], v[96:99], 0
    v_mfma_f32_16x16x32_bf16 v[160:163], v[32:35], v[100:103], 0
    s_waitcnt lgkmcnt(6)
    v_mfma_f32_16x16x32_bf16 v[12:15], v[36:39], v[104:107], v[12:15]
    v_mfma_f32_16x16x32_bf16 v[160:163], v[36:39], v[108:111], v[160:163]
    s_waitcnt lgkmcnt(5)
    v_mfma_f32_16x16x32_bf16 v[12:15], v[40:43], v[112:115], v[12:15]
    v_mfma_f32_16x16x32_bf16 v[160:163], v[40:43], v[116:119], v[160:163]
    s_waitcnt lgkmcnt(4)
    v_mfma_f32_16x16x32_bf16 v[12:15], v[44:47], v[120:123], v[12:15]
    v_mfma_f32_16x16x32_bf16 v[160:163], v[44:47], v[124:127], v[160:163]
    s_waitcnt lgkmcnt(3)
    v_mfma_f32_16x16x32_bf16 v[12:15], v[48:51], v[128:131], v[12:15]
    v_mfma_f32_16x16x32_bf16 v[160:163], v[48:51], v[132:135], v[160:163]
    s_waitcnt lgkmcnt(2)
    v_mfma_f32_16x16x32_bf16 v[12:15], v[52:55], v[136:139], v[12:15]
    v_mfma_f32_16x16x32_bf16 v[160:163], v[52:55], v[140:143], v[160:163]
    s_waitcnt lgkmcnt(1)
    v_mfma_f32_16x16x32_bf16 v[12:15], v[56:59], v[144:147], v[12:15]
    v_mfma_f32_16x16x32_bf16 v[160:163], v[56:59], v[148:151], v[160:163]
    s_waitcnt lgkmcnt(0)
    v_mfma_f32_16x16x32_bf16 v[12:15], v[60:63], v[152:155], v[12:15]
    v_mfma_f32_16x16x32_bf16 v[160:163], v[60:63], v[156:159], v[160:163]
    s_nop 6
    v_min_u32 v12, -2, v12
    v_min_u32 v160, -2, v160
    s_nop 0
    v_mov_b32 v13, v12 quad_perm:[1,1,1,1]
    v_mov_b32 v14, v12 quad_perm:[2,2,2,2]
    v_mov_b32 v15, v12 quad_perm:[3,3,3,3]
    v_mov_b32 v161, v160 quad_perm:[1,1,1,1]
    v_mov_b32 v162, v160 quad_perm:[2,2,2,2]
    v_mov_b32 v163, v160 quad_perm:[3,3,3,3]
    s_mov_b64 exec, 0x1111
    buffer_store_dwordx4 v[12:15], v27, s[52:55], s15 offen sc1
    buffer_store_dwordx4 v[160:163], v27, s[52:55], s15 offen offset:64 sc1
    s_mov_b64 exec, -1
    s_cmp_lg_u32 s3, 0
    s_nop 2
    s_cbranch_scc1 k2_g_nopub
    v_and_b32 v33, 12, v1
    v_lshlrev_b32 v33, 7, v33
    v_and_b32 v35, 16, v1
    v_lshl_add_u32 v33, v35, 2, v33
    v_lshl_add_u32 v33, v18, 4, v33
    s_lshl_b32 s13, s8, 7
    s_add_u32 s13, s13, s12
    s_nop 2
k2_gpoll:
    buffer_load_dwordx4 v[40:43], v33, s[52:55], s13 offen sc1
    s_waitcnt vmcnt(0)
    v_max3_u32 v44, v40, v41, v42
    v_max_u32 v44, v44, v43
    v_cmp_ne_u32 vcc, -1, v44
    s_cmp_eq_u64 vcc, -1
    s_cbranch_scc1 k2_gpoll_done
    s_sleep 2
    s_branch k2_gpoll
k2_gpoll_done:
    s_nop 0
    v_add_f32 v40, v40, v40 row_ror:4
    v_add_f32 v41, v41, v41 row_ror:4
    v_add_f32 v42, v42, v42 row_ror:4
    v_add_f32 v43, v43, v43 row_ror:4
    v_add_f32 v40, v40, v40 row_ror:8
    v_add_f32 v41, v41, v41 row_ror:8
    v_add_f32 v42, v42, v42 row_ror:8
    v_add_f32 v43, v43, v43 row_ror:8
    v_cvt_pk_bf16_f32 v40, 0, v40
    v_cvt_pk_bf16_f32 v41, 0, v41
    v_cvt_pk_bf16_f32 v42, 0, v42
    v_cvt_pk_bf16_f32 v43, 0, v43
    v_mov_b32 v44, v40
    v_mov_b32 v45, v41
    v_mov_b32 v46, v42
    v_mov_b32 v47, v43
    v_permlane16_swap_b32 v40, v44
    v_permlane16_swap_b32 v41, v45
    v_permlane16_swap_b32 v42, v46
    v_permlane16_swap_b32 v43, v47
    v_mul_f32 v36, 0xbfb8aa3b, v40
    v_mul_f32 v37, 0xbfb8aa3b, v41
    v_mul_f32 v38, 0xbfb8aa3b, v42
    v_mul_f32 v39, 0xbfb8aa3b, v43
    v_exp_f32 v36, v36
    v_exp_f32 v37, v37
    v_exp_f32 v38, v38
    v_exp_f32 v39, v39
    v_add_f32 v36, 1.0, v36
    v_add_f32 v37, 1.0, v37
    v_add_f32 v38, 1.0, v38
    v_add_f32 v39, 1.0, v39
    v_rcp_f32 v36, v36
    v_rcp_f32 v37, v37
    v_rcp_f32 v38, v38
    v_rcp_f32 v39, v39
    v_mul_f32 v40, v40, v36
    v_mul_f32 v41, v41, v37
    v_mul_f32 v42, v42, v38
    v_mul_f32 v43, v43, v39
    v_cvt_pk_bf16_f32 v40, 0, v40
    v_cvt_pk_bf16_f32 v41, 0, v41
    v_cvt_pk_bf16_f32 v42, 0, v42
    v_cvt_pk_bf16_f32 v43, 0, v43
    v_mul_f32 v40, v40, v44
    v_mul_f32 v41, v41, v45
    v_mul_f32 v42, v42, v46
    v_mul_f32 v43, v43, v47
    v_cvt_pk_bf16_f32 v40, v40, v41
    v_cvt_pk_bf16_f32 v41, v42, v43
    v_lshlrev_b32 v32, 3, v1
    v_add_u32 v32, 142976, v32
    s_mov_b64 exec, 15
    ds_write_b64 v32, v[40:41]
    s_mov_b64 exec, -1
    s_waitcnt lgkmcnt(0)
    s_mov_b64 exec, 1
    ds_add_u32 v6, v7 offset:16
    s_mov_b64 exec, -1
k2_g_nopub:
    s_lshl_b32 s13, s7, 2
    s_add_u32 s13, s13, s8
    s_lshl_b32 s13, s13, 12
    s_add_u32 s13, s13, 0x600000
    s_lshl_b32 s14, s3, 10
    s_add_u32 s13, s13, s14
k2_ph:
    ds_read_b32 v8, v6 offset:16
    s_waitcnt lgkmcnt(0)
    v_readfirstlane_b32 s14, v8
    s_cmp_ge_u32 s14, 1
    s_cbranch_scc1 k2_ph_done
    s_sleep 1
    s_branch k2_ph
k2_ph_done:
    s_nop 0
    ds_read_b64 v[32:33], v28
    ds_read_b64 v[34:35], v29
    ds_read_b64 v[36:37], v30
    ds_read_b64 v[38:39], v31
    s_waitcnt lgkmcnt(0)
    v_mfma_f32_16x16x16_bf16 v[48:51], v[32:33], v[64:65], 0
    v_mfma_f32_16x16x16_bf16 v[48:51], v[34:35], v[66:67], v[48:51]
    v_mfma_f32_16x16x16_bf16 v[48:51], v[36:37], v[68:69], v[48:51]
    v_mfma_f32_16x16x16_bf16 v[48:51], v[38:39], v[70:71], v[48:51]
    v_mfma_f32_16x16x16_bf16 v[52:55], v[32:33], v[72:73], 0
    v_mfma_f32_16x16x16_bf16 v[52:55], v[34:35], v[74:75], v[52:55]
    v_mfma_f32_16x16x16_bf16 v[52:55], v[36:37], v[76:77], v[52:55]
    v_mfma_f32_16x16x16_bf16 v[52:55], v[38:39], v[78:79], v[52:55]
    v_mfma_f32_16x16x16_bf16 v[56:59], v[32:33], v[80:81], 0
    v_mfma_f32_16x16x16_bf16 v[56:59], v[34:35], v[82:83], v[56:59]
    v_mfma_f32_16x16x16_bf16 v[56:59], v[36:37], v[84:85], v[56:59]
    v_mfma_f32_16x16x16_bf16 v[56:59], v[38:39], v[86:87], v[56:59]
    v_mfma_f32_16x16x16_bf16 v[60:63], v[32:33], v[88:89], 0
    v_mfma_f32_16x16x16_bf16 v[60:63], v[34:35], v[90:91], v[60:63]
    v_mfma_f32_16x16x16_bf16 v[60:63], v[36:37], v[92:93], v[60:63]
    v_mfma_f32_16x16x16_bf16 v[60:63], v[38:39], v[94:95], v[60:63]
    v_min_u32 v48, -2, v48
    v_min_u32 v52, -2, v52
    s_nop 1
    v_min_u32 v56, -2, v56
    s_nop 2
    v_min_u32 v60, -2, v60
    v_mov_b32 v49, v48 quad_perm:[1,1,1,1]
    v_mov_b32 v50, v48 quad_perm:[2,2,2,2]
    v_mov_b32 v51, v48 quad_perm:[3,3,3,3]
    v_mov_b32 v53, v52 quad_perm:[1,1,1,1]
    v_mov_b32 v54, v52 quad_perm:[2,2,2,2]
    v_mov_b32 v55, v52 quad_perm:[3,3,3,3]
    v_mov_b32 v57, v56 quad_perm:[1,1,1,1]
    v_mov_b32 v58, v56 quad_perm:[2,2,2,2]
    v_mov_b32 v59, v56 quad_perm:[3,3,3,3]
    v_mov_b32 v61, v60 quad_perm:[1,1,1,1]
    v_mov_b32 v62, v60 quad_perm:[2,2,2,2]
    v_mov_b32 v63, v60 quad_perm:[3,3,3,3]
    s_mov_b32 exec_lo, 0x11111111
    s_mov_b32 exec_hi, 0x11111111
    buffer_store_dwordx4 v[48:51], v27, s[52:55], s13 offen offset:0 sc1
    buffer_store_dwordx4 v[52:55], v27, s[52:55], s13 offen offset:256 sc1
    buffer_store_dwordx4 v[56:59], v27, s[52:55], s13 offen offset:512 sc1
    buffer_store_dwordx4 v[60:63], v27, s[52:55], s13 offen offset:768 sc1
    s_endpgm
k2_R:
    s_nop 3
    s_waitcnt vmcnt(0)
    s_waitcnt lgkmcnt(0)
    s_mov_b64 exec, 1
    ds_add_u32 v6, v7 offset:36
    s_mov_b64 exec, -1
    s_cmp_lg_u32 s3, 3
    s_cbranch_scc1 k2_r_nomaster
    s_cmp_lg_u32 s2, 255
    s_cbranch_scc1 k2_r_nomaster
    v_lshlrev_b32 v8, 4, v1
    v_lshlrev_b32 v9, 7, v1
    v_mov_b32 v12, v44
    v_mov_b32 v14, v44
    s_mov_b32 s25, 0x5f0000
    s_mov_b32 s26, 0x5f8000
    s_nop 2
k2_mw:
    ds_read_b32 v11, v6 offset:36
    s_waitcnt lgkmcnt(0)
    v_readfirstlane_b32 s14, v11
    s_cmp_ge_u32 s14, 8
    s_cbranch_scc1 k2_mw_done
    s_sleep 1
    s_branch k2_mw
k2_mw_done:
    s_nop 0
    buffer_load_dwordx2 v[16:17], v8, s[52:55], s26 offen offset:0 sc1
    buffer_load_dwordx2 v[18:19], v8, s[52:55], s26 offen offset:1024 sc1
    buffer_load_dwordx2 v[20:21], v8, s[52:55], s26 offen offset:2048 sc1
    buffer_load_dwordx2 v[22:23], v8, s[52:55], s26 offen offset:3072 sc1
k2_master:
    s_sleep 8
    buffer_load_dwordx2 v[24:25], v8, s[52:55], s26 offen offset:0 sc1
    buffer_load_dwordx2 v[26:27], v8, s[52:55], s26 offen offset:1024 sc1
    buffer_load_dwordx2 v[28:29], v8, s[52:55], s26 offen offset:2048 sc1
    buffer_load_dwordx2 v[30:31], v8, s[52:55], s26 offen offset:3072 sc1
    s_waitcnt vmcnt(4)
    v_xor_b32 v48, v16, v12
    v_xor_b32 v49, v18, v12
    v_xor_b32 v50, v20, v12
    v_xor_b32 v51, v22, v12
    v_or3_b32 v48, v48, v49, v50
    v_or_b32 v48, v48, v51
    v_max3_u32 v13, v17, v19, v21
    v_cmp_eq_u32 vcc, 0, v48
    v_max_u32 v13, v13, v23
    s_cmp_eq_u64 vcc, -1
    s_cbranch_scc1 k2_master_done
    s_nop 2
    s_sleep 8
    buffer_load_dwordx2 v[16:17], v8, s[52:55], s26 offen offset:0 sc1
    buffer_load_dwordx2 v[18:19], v8, s[52:55], s26 offen offset:1024 sc1
    buffer_load_dwordx2 v[20:21], v8, s[52:55], s26 offen offset:2048 sc1
    buffer_load_dwordx2 v[22:23], v8, s[52:55], s26 offen offset:3072 sc1
    s_waitcnt vmcnt(4)
    v_xor_b32 v48, v24, v12
    v_xor_b32 v49, v26, v12
    v_xor_b32 v50, v28, v12
    v_xor_b32 v51, v30, v12
    v_or3_b32 v48, v48, v49, v50
    v_or_b32 v48, v48, v51
    v_max3_u32 v13, v25, v27, v29
    v_cmp_eq_u32 vcc, 0, v48
    v_max_u32 v13, v13, v31
    s_cmp_eq_u64 vcc, -1
    s_cbranch_scc1 k2_master_done
    s_nop 2
    s_branch k2_master
k2_master_done:
    v_mov_b32 v15, v13
    s_nop 1
    v_permlane32_swap_b32 v13, v15
    v_max_u32 v13, v13, v15
    v_mov_b32 v15, v13
    s_nop 1
    v_permlane16_swap_b32 v13, v15
    v_max_u32 v13, v13, v15
    s_nop 1
    v_max_u32 v13, v13, v13 row_ror:8
    s_nop 1
    v_max_u32 v13, v13, v13 row_ror:4
    s_nop 1
    v_max_u32 v13, v13, v13 row_ror:2
    s_nop 1
    v_max_u32 v13, v13, v13 row_ror:1
    v_mov_b32 v15, v13
    buffer_store_dwordx4 v[12:15], v9, s[52:55], s25 offen sc1
    s_waitcnt vmcnt(0)
k2_r_nomaster:
    s_nop 3
    s_lshl_b32 s9, s4, 2
    s_add_u32 s9, s9, s5
    s_sub_u32 s9, s9, 28
    v_lshrrev_b32 v2, 3, v1
    v_and_b32 v3, 7, v1
    v_lshlrev_b32 v4, 12, v2
    v_lshl_add_u32 v4, v3, 4, v4
    s_mul_i32 s10, s3, 229376
    s_lshl_b32 s11, s9, 7
    s_add_u32 s10, s10, s11
    s_add_u32 s10, s10, 0x600000
    v_mov_b32 v6, 143040
    v_mov_b32 v7, 1
    v_and_b32 v5, 31, v1
    v_lshlrev_b32 v8, 1, v5
    v_lshlrev_b32 v9, 12, v5
    v_lshlrev_b32 v10, 2, v5
    v_mov_b32 v11, 0
    s_mov_b32 s17, 0
    v_mov_b32 v26, -1
    s_cmp_lg_u32 s3, 0
    s_nop 3
    s_cbranch_scc1 k2_r_poll
k2_rk:
    ds_read_b32 v12, v6 offset:4
    s_waitcnt lgkmcnt(0)
    v_readfirstlane_b32 s14, v12
    s_cmp_ge_u32 s14, 1
    s_cbranch_scc1 k2_rk_done
    s_sleep 1
    s_branch k2_rk
k2_rk_done:
    s_nop 0
    ds_read_b32 v16, v6 offset:24
    s_waitcnt lgkmcnt(0)
    v_readfirstlane_b32 s14, v16
    s_and_b32 s15, s14, 0x7ff
    s_sub_u32 s15, 2047, s15
    s_lshl_b32 s12, s9, 6
    s_lshl_b32 s13, s15, 11
    s_add_u32 s13, s13, s12
    s_lshl_b32 s16, s15, 3
    s_add_u32 s16, s16, 0x400000
    buffer_load_ushort v20, v8, s[48:51], s13 offen
    buffer_load_ushort v21, v8, s[56:59], s12 offen
    buffer_load_dwordx2 v[22:23], v11, s[52:55], s16 offen
    v_and_b32 v16, 0xffff0000, v16
    v_ashrrev_i32 v17, 31, v16
    v_not_b32 v17, v17
    v_or_b32 v17, 0x80000000, v17
    v_xor_b32 v16, v16, v17
    v_and_b32 v16, 0xffff0000, v16
    v_mul_f32 v16, 0xbfb8aa3b, v16
    v_exp_f32 v16, v16
    s_nop 0
    v_add_f32 v16, 1.0, v16
    v_rcp_f32 v16, v16
    s_nop 0
    v_cvt_pk_bf16_f32 v16, 0, v16
    s_lshr_b32 s16, s9, 2
    s_lshl_b32 s16, s16, 12
    s_lshr_b32 s17, s15, 8
    s_lshl_b32 s17, s17, 9
    s_add_u32 s16, s16, s17
    s_and_b32 s17, s9, 3
    s_lshl_b32 s17, s17, 7
    s_add_u32 s16, s16, s17
    s_add_u32 s16, s16, 0x5e0000
    s_lshl_b32 s17, s9, 17
    s_lshr_b32 s18, s15, 1
    s_lshl_b32 s18, s18, 2
    s_add_u32 s17, s17, s18
    s_and_b32 s27, s15, 1
    s_lshl_b32 s27, s27, 4
    s_waitcnt vmcnt(0)
    v_lshlrev_b32 v20, 16, v20
    v_lshlrev_b32 v21, 16, v21
    v_sub_f32 v24, v20, v22
    v_cvt_pk_bf16_f32 v24, 0, v24
    v_mul_f32 v24, v24, v23
    v_cvt_pk_bf16_f32 v24, 0, v24
    v_mul_f32 v21, v21, v24
    v_cvt_pk_bf16_f32 v21, 0, v21
k2_r_poll:
    s_nop 4
    s_mov_b32 s19, 28
k2_rg2:
    ds_read_b32 v12, v6 offset:28
    s_waitcnt lgkmcnt(0)
    v_readfirstlane_b32 s20, v12
    s_cmp_ge_u32 s20, s19
    s_cbranch_scc1 k2_rg2_done
    s_sleep 2
    s_branch k2_rg2
k2_rg2_done:
    s_nop 0
k2_rp:
    s_mov_b32 s18, s10
    buffer_load_dword v25, v9, s[52:55], s17 offen sc1
    buffer_load_dwordx4 v[32:35], v4, s[52:55], s18 offen sc1
    s_add_u32 s18, s18, 0x8000
    buffer_load_dwordx4 v[36:39], v4, s[52:55], s18 offen sc1
    s_add_u32 s18, s18, 0x8000
    buffer_load_dwordx4 v[40:43], v4, s[52:55], s18 offen sc1
    s_add_u32 s18, s18, 0x8000
    buffer_load_dwordx4 v[44:47], v4, s[52:55], s18 offen sc1
    s_add_u32 s18, s18, 0x8000
    buffer_load_dwordx4 v[48:51], v4, s[52:55], s18 offen sc1
    s_add_u32 s18, s18, 0x8000
    buffer_load_dwordx4 v[52:55], v4, s[52:55], s18 offen sc1
    s_add_u32 s18, s18, 0x8000
    buffer_load_dwordx4 v[56:59], v4, s[52:55], s18 offen sc1
    s_waitcnt vmcnt(0)
    v_max3_u32 v60, v32, v33, v34
    v_max3_u32 v60, v60, v35, v36
    v_max3_u32 v60, v60, v37, v38
    v_max3_u32 v60, v60, v39, v40
    v_max3_u32 v60, v60, v41, v42
    v_max3_u32 v60, v60, v43, v44
    v_max3_u32 v60, v60, v45, v46
    v_max3_u32 v60, v60, v47, v48
    v_max3_u32 v60, v60, v49, v50
    v_max3_u32 v60, v60, v51, v52
    v_max3_u32 v60, v60, v53, v54
    v_max3_u32 v60, v60, v55, v56
    v_max3_u32 v60, v60, v57, v58
    v_max_u32 v60, v60, v59
    v_cmp_ne_u32 vcc, -1, v60
    s_cmp_eq_u64 vcc, -1
    s_cbranch_scc1 k2_rp_done
    s_sleep 2
    s_branch k2_rp
k2_rp_done:
    s_nop 0
    v_add_f32 v32, v32, v36
    v_add_f32 v33, v33, v37
    v_add_f32 v34, v34, v38
    v_add_f32 v35, v35, v39
    v_add_f32 v40, v40, v44
    v_add_f32 v41, v41, v45
    v_add_f32 v42, v42, v46
    v_add_f32 v43, v43, v47
    v_add_f32 v48, v48, v52
    v_add_f32 v49, v49, v53
    v_add_f32 v50, v50, v54
    v_add_f32 v51, v51, v55
    v_add_f32 v32, v32, v40
    v_add_f32 v33, v33, v41
    v_add_f32 v34, v34, v42
    v_add_f32 v35, v35, v43
    v_add_f32 v48, v48, v56
    v_add_f32 v49, v49, v57
    v_add_f32 v50, v50, v58
    v_add_f32 v51, v51, v59
    v_add_f32 v32, v32, v48
    v_add_f32 v33, v33, v49
    v_add_f32 v34, v34, v50
    v_add_f32 v35, v35, v51
    v_mov_b32 v36, v32
    v_mov_b32 v37, v33
    v_mov_b32 v38, v34
    v_mov_b32 v39, v35
    v_permlane32_swap_b32 v32, v36
    v_permlane32_swap_b32 v33, v37
    v_permlane32_swap_b32 v34, v38
    v_permlane32_swap_b32 v35, v39
    v_add_f32 v32, v32, v36
    v_add_f32 v33, v33, v37
    v_add_f32 v34, v34, v38
    v_add_f32 v35, v35, v39
    v_mov_b32 v36, v32
    v_mov_b32 v37, v33
    v_mov_b32 v38, v34
    v_mov_b32 v39, v35
    v_permlane16_swap_b32 v32, v36
    v_permlane16_swap_b32 v33, v37
    v_permlane16_swap_b32 v34, v38
    v_permlane16_swap_b32 v35, v39
    v_add_f32 v32, v32, v36
    v_add_f32 v33, v33, v37
    v_add_f32 v34, v34, v38
    v_add_f32 v35, v35, v39
    v_add_f32 v32, v32, v32 row_ror:8
    v_add_f32 v33, v33, v33 row_ror:8
    v_add_f32 v34, v34, v34 row_ror:8
    v_add_f32 v35, v35, v35 row_ror:8
    s_lshl_b32 s18, s3, 7
    s_add_u32 s18, s18, 141440
    v_lshlrev_b32 v12, 4, v3
    v_add_u32 v12, s18, v12
    s_mov_b64 exec, 0xff
    ds_write_b128 v12, v[32:35]
    s_mov_b64 exec, -1
    s_waitcnt lgkmcnt(0)
    s_mov_b64 exec, 1
    ds_add_u32 v6, v7 offset:8
    s_mov_b64 exec, -1
    s_cmp_lg_u32 s3, 0
    s_cbranch_scc1 k2_r_fin
k2_ryp:
    v_cmp_ne_u32 vcc, v26, v25
    s_cmp_eq_u64 vcc, -1
    s_cbranch_scc1 k2_ryp_done
    buffer_load_dword v25, v9, s[52:55], s17 offen sc1
    s_waitcnt vmcnt(0)
    s_branch k2_ryp
k2_ryp_done:
    v_lshrrev_b32 v25, s27, v25
    v_lshlrev_b32 v25, 16, v25
    v_add_f32 v21, v21, v25
    v_cvt_pk_bf16_f32 v21, 0, v21
    v_add_f32 v21, v21, v20
    v_cvt_pk_bf16_f32 v21, 0, v21
    s_nop 4
k2_rs:
    ds_read_b32 v12, v6 offset:8
    s_waitcnt lgkmcnt(0)
    v_readfirstlane_b32 s14, v12
    s_cmp_ge_u32 s14, 4
    s_cbranch_scc1 k2_rs_done
    s_sleep 1
    s_branch k2_rs
k2_rs_done:
    s_nop 0
    v_add_u32 v12, 141440, v10
    ds_read_b32 v32, v12 offset:0
    ds_read_b32 v33, v12 offset:128
    ds_read_b32 v34, v12 offset:256
    ds_read_b32 v35, v12 offset:384
    s_waitcnt lgkmcnt(0)
    v_add_f32 v32, v32, v33
    v_add_f32 v34, v34, v35
    v_add_f32 v32, v32, v34
    v_cvt_pk_bf16_f32 v32, 0, v32
    v_mul_f32 v32, v16, v32
    v_cvt_pk_bf16_f32 v32, 0, v32
    v_add_f32 v32, v32, v24
    v_cvt_pk_bf16_f32 v32, 0, v32
    v_add_f32 v32, v32, v21
    v_cvt_pk_bf16_f32 v32, v32, v32
    s_mov_b32 exec_hi, 0
    buffer_store_short v32, v8, s[72:75], s13 offen
k2_r_fin:
    s_nop 2
    s_endpgm
k2_E:
    s_mov_b32 s48, s16
    s_and_b32 s49, s17, 0xffff
    s_mov_b32 s50, 0x400000
    s_mov_b32 s51, 0x20000
    s_mov_b32 s60, s32
    s_and_b32 s61, s33, 0xffff
    s_mov_b32 s62, 0x800
    s_mov_b32 s63, 0x20000
    s_mov_b32 s56, s28
    s_and_b32 s57, s29, 0xffff
    s_mov_b32 s58, 0x800
    s_mov_b32 s59, 0x20000
    s_mov_b32 s72, s40
    s_and_b32 s73, s41, 0xffff
    s_mov_b32 s74, 0x400000
    s_mov_b32 s75, 0x20000
    s_mov_b32 s76, s42
    s_and_b32 s77, s43, 0xffff
    s_mov_b32 s78, 0x100
    s_mov_b32 s79, 0x20000
    s_setprio 3
    s_sub_u32 s3, s3, 8
    v_lshlrev_b32 v2, 4, v1
    s_lshl_b32 s20, s2, 3
    s_lshl_b32 s9, s3, 1
    s_add_u32 s20, s20, s9
    s_lshl_b32 s9, s20, 11
    s_add_u32 s10, s9, 2048
    buffer_load_dwordx4 v[8:11], v2, s[48:51], s9 offen nt
    buffer_load_dwordx4 v[12:15], v2, s[48:51], s9 offen offset:1024 nt
    buffer_load_dwordx4 v[16:19], v2, s[48:51], s10 offen nt
    buffer_load_dwordx4 v[20:23], v2, s[48:51], s10 offen offset:1024 nt
    buffer_load_dwordx4 v[24:27], v2, s[60:63], 0 offen
    buffer_load_dwordx4 v[28:31], v2, s[60:63], 0 offen offset:1024
    s_barrier
    v_mov_b32 v44, 0
    s_lshr_b32 s24, s2, 2
    s_lshl_b32 s24, s24, 7
    s_add_u32 s24, s24, 0x5f0000
    v_subrev_u32 v35, 512, v0
    v_mul_u32_u24 v3, 144, v1
    s_lshl_b32 s9, s3, 2
    v_add_u32 v3, s9, v3
    v_add_u32 v4, 9216, v3
    v_lshrrev_b32 v5, 3, v35
    v_add_u32 v5, v5, v35
    v_lshlrev_b32 v5, 4, v5
    v_lshrrev_b32 v6, 2, v35
    v_lshlrev_b32 v6, 14, v6
    v_and_b32 v7, 3, v35
    v_lshl_add_u32 v6, v7, 4, v6
    v_mov_b32 v32, 0x3f80
    v_mov_b32 v33, 0x3f800000
    v_mov_b32 v34, 0x3f803f80
    v_mov_b32 v56, 143040
    v_mov_b32 v57, 1
    s_lshl_b32 s10, s2, 6
    s_add_u32 s10, s10, 0xa00000
    s_waitcnt vmcnt(2)
    v_dot2_f32_bf16 v36, v8, v34, 0
    v_dot2_f32_bf16 v37, v16, v34, 0
    v_dot2_f32_bf16 v36, v9, v34, v36
    v_dot2_f32_bf16 v37, v17, v34, v37
    v_dot2_f32_bf16 v36, v10, v34, v36
    v_dot2_f32_bf16 v37, v18, v34, v37
    v_dot2_f32_bf16 v36, v11, v34, v36
    v_dot2_f32_bf16 v37, v19, v34, v37
    v_dot2_f32_bf16 v36, v12, v34, v36
    v_dot2_f32_bf16 v37, v20, v34, v37
    v_dot2_f32_bf16 v36, v13, v34, v36
    v_dot2_f32_bf16 v37, v21, v34, v37
    v_dot2_f32_bf16 v36, v14, v34, v36
    v_dot2_f32_bf16 v37, v22, v34, v37
    v_dot2_f32_bf16 v36, v15, v34, v36
    v_dot2_f32_bf16 v37, v23, v34, v37
    s_nop 2
    v_permlane32_swap_b32 v36, v37
    v_add_f32 v36, v36, v37
    v_mov_b32 v38, v36
    s_nop 1
    v_permlane16_swap_b32 v36, v38
    v_add_f32 v36, v36, v38
    s_nop 1
    v_add_f32 v36, v36, v36 row_ror:8
    s_nop 1
    v_add_f32 v36, v36, v36 row_ror:4
    s_nop 1
    v_add_f32 v36, v36, v36 row_ror:2
    s_nop 1
    v_add_f32 v36, v36, v36 row_ror:1
    v_mul_f32 v36, 0xba800000, v36
    v_cvt_pk_bf16_f32 v39, 0, v36
    v_xor_b32 v38, 0x80000000, v39
    v_readlane_b32 s14, v39, 0
    v_readlane_b32 s15, v39, 32
    v_sub_f32 v36, v39, v36
    v_dot2_f32_bf16 v64, v8, v32, s14
    v_dot2_f32_bf16 v65, v8, v33, s14
    v_dot2_f32_bf16 v66, v9, v32, s14
    v_dot2_f32_bf16 v67, v9, v33, s14
    v_dot2_f32_bf16 v68, v10, v32, s14
    v_dot2_f32_bf16 v69, v10, v33, s14
    v_dot2_f32_bf16 v70, v11, v32, s14
    v_dot2_f32_bf16 v71, v11, v33, s14
    v_dot2_f32_bf16 v72, v12, v32, s14
    v_dot2_f32_bf16 v73, v12, v33, s14
    v_dot2_f32_bf16 v74, v13, v32, s14
    v_dot2_f32_bf16 v75, v13, v33, s14
    v_dot2_f32_bf16 v76, v14, v32, s14
    v_dot2_f32_bf16 v77, v14, v33, s14
    v_dot2_f32_bf16 v78, v15, v32, s14
    v_dot2_f32_bf16 v79, v15, v33, s14
    v_dot2_f32_bf16 v80, v16, v32, s15
    v_dot2_f32_bf16 v81, v16, v33, s15
    v_dot2_f32_bf16 v82, v17, v32, s15
    v_dot2_f32_bf16 v83, v17, v33, s15
    v_dot2_f32_bf16 v84, v18, v32, s15
    v_dot2_f32_bf16 v85, v18, v33, s15
    v_dot2_f32_bf16 v86, v19, v32, s15
    v_dot2_f32_bf16 v87, v19, v33, s15
    v_dot2_f32_bf16 v88, v20, v32, s15
    v_dot2_f32_bf16 v89, v20, v33, s15
    v_dot2_f32_bf16 v90, v21, v32, s15
    v_dot2_f32_bf16 v91, v21, v33, s15
    v_dot2_f32_bf16 v92, v22, v32, s15
    v_dot2_f32_bf16 v93, v22, v33, s15
    v_dot2_f32_bf16 v94, v23, v32, s15
    v_dot2_f32_bf16 v95, v23, v33, s15
    v_mul_f32 v60, v64, v64
    v_mul_f32 v61, v80, v80
    v_mul_f32 v62, v65, v65
    v_mul_f32 v63, v81, v81
    v_fmac_f32 v60, v66, v66
    v_fmac_f32 v61, v82, v82
    v_fmac_f32 v62, v67, v67
    v_fmac_f32 v63, v83, v83
    v_fmac_f32 v60, v68, v68
    v_fmac_f32 v61, v84, v84
    v_fmac_f32 v62, v69, v69
    v_fmac_f32 v63, v85, v85
    v_fmac_f32 v60, v70, v70
    v_fmac_f32 v61, v86, v86
    v_fmac_f32 v62, v71, v71
    v_fmac_f32 v63, v87, v87
    v_fmac_f32 v60, v72, v72
    v_fmac_f32 v61, v88, v88
    v_fmac_f32 v62, v73, v73
    v_fmac_f32 v63, v89, v89
    v_fmac_f32 v60, v74, v74
    v_fmac_f32 v61, v90, v90
    v_fmac_f32 v62, v75, v75
    v_fmac_f32 v63, v91, v91
    v_fmac_f32 v60, v76, v76
    v_fmac_f32 v61, v92, v92
    v_fmac_f32 v62, v77, v77
    v_fmac_f32 v63, v93, v93
    v_fmac_f32 v60, v78, v78
    v_fmac_f32 v61, v94, v94
    v_fmac_f32 v62, v79, v79
    v_fmac_f32 v63, v95, v95
    v_add_f32 v60, v60, v62
    v_add_f32 v61, v61, v63
    v_mul_f32 v36, v36, v36
    s_nop 0
    v_permlane32_swap_b32 v60, v61
    v_add_f32 v60, v60, v61
    v_mov_b32 v62, v60
    s_nop 1
    v_permlane16_swap_b32 v60, v62
    v_add_f32 v60, v60, v62
    s_nop 1
    v_add_f32 v60, v60, v60 row_ror:8
    s_nop 1
    v_add_f32 v60, v60, v60 row_ror:4
    s_nop 1
    v_add_f32 v60, v60, v60 row_ror:2
    s_nop 1
    v_add_f32 v60, v60, v60 row_ror:1
    v_mov_b32 v61, 0x3a800000
    v_fma_f32 v60, v60, v61, -v36
    v_max_f32 v60, 0, v60
    v_cvt_pk_bf16_f32 v60, 0, v60
    v_add_f32 v60, 0x3727c5ac, v60
    v_cvt_pk_bf16_f32 v60, 0, v60
    v_sqrt_f32 v60, v60
    s_nop 0
    v_cvt_pk_bf16_f32 v60, 0, v60
    v_rcp_f32 v39, v60
    v_cvt_pk_bf16_f32 v64, 0, v64
    v_cvt_pk_bf16_f32 v65, 0, v65
    v_cvt_pk_bf16_f32 v66, 0, v66
    v_cvt_pk_bf16_f32 v67, 0, v67
    v_cvt_pk_bf16_f32 v68, 0, v68
    v_cvt_pk_bf16_f32 v69, 0, v69
    v_cvt_pk_bf16_f32 v70, 0, v70
    v_cvt_pk_bf16_f32 v71, 0, v71
    v_cvt_pk_bf16_f32 v72, 0, v72
    v_cvt_pk_bf16_f32 v73, 0, v73
    v_cvt_pk_bf16_f32 v74, 0, v74
    v_cvt_pk_bf16_f32 v75, 0, v75
    v_cvt_pk_bf16_f32 v76, 0, v76
    v_cvt_pk_bf16_f32 v77, 0, v77
    v_cvt_pk_bf16_f32 v78, 0, v78
    v_cvt_pk_bf16_f32 v79, 0, v79
    v_cvt_pk_bf16_f32 v80, 0, v80
    v_cvt_pk_bf16_f32 v81, 0, v81
    v_cvt_pk_bf16_f32 v82, 0, v82
    v_cvt_pk_bf16_f32 v83, 0, v83
    v_cvt_pk_bf16_f32 v84, 0, v84
    v_cvt_pk_bf16_f32 v85, 0, v85
    v_cvt_pk_bf16_f32 v86, 0, v86
    v_cvt_pk_bf16_f32 v87, 0, v87
    v_cvt_pk_bf16_f32 v88, 0, v88
    v_cvt_pk_bf16_f32 v89, 0, v89
    v_cvt_pk_bf16_f32 v90, 0, v90
    v_cvt_pk_bf16_f32 v91, 0, v91
    v_cvt_pk_bf16_f32 v92, 0, v92
    v_cvt_pk_bf16_f32 v93, 0, v93
    v_cvt_pk_bf16_f32 v94, 0, v94
    v_cvt_pk_bf16_f32 v95, 0, v95
    v_readlane_b32 s14, v39, 0
    v_readlane_b32 s15, v39, 32
    s_nop 0
    v_mul_f32 v64, s14, v64
    v_mul_f32 v65, s14, v65
    v_mul_f32 v66, s14, v66
    v_mul_f32 v67, s14, v67
    v_mul_f32 v68, s14, v68
    v_mul_f32 v69, s14, v69
    v_mul_f32 v70, s14, v70
    v_mul_f32 v71, s14, v71
    v_mul_f32 v72, s14, v72
    v_mul_f32 v73, s14, v73
    v_mul_f32 v74, s14, v74
    v_mul_f32 v75, s14, v75
    v_mul_f32 v76, s14, v76
    v_mul_f32 v77, s14, v77
    v_mul_f32 v78, s14, v78
    v_mul_f32 v79, s14, v79
    v_mul_f32 v80, s15, v80
    v_mul_f32 v81, s15, v81
    v_mul_f32 v82, s15, v82
    v_mul_f32 v83, s15, v83
    v_mul_f32 v84, s15, v84
    v_mul_f32 v85, s15, v85
    v_mul_f32 v86, s15, v86
    v_mul_f32 v87, s15, v87
    v_mul_f32 v88, s15, v88
    v_mul_f32 v89, s15, v89
    v_mul_f32 v90, s15, v90
    v_mul_f32 v91, s15, v91
    v_mul_f32 v92, s15, v92
    v_mul_f32 v93, s15, v93
    v_mul_f32 v94, s15, v94
    v_mul_f32 v95, s15, v95
    v_cvt_pk_bf16_f32 v96, v64, v65
    v_cvt_pk_bf16_f32 v97, v66, v67
    v_cvt_pk_bf16_f32 v98, v68, v69
    v_cvt_pk_bf16_f32 v99, v70, v71
    v_cvt_pk_bf16_f32 v100, v72, v73
    v_cvt_pk_bf16_f32 v101, v74, v75
    v_cvt_pk_bf16_f32 v102, v76, v77
    v_cvt_pk_bf16_f32 v103, v78, v79
    v_cvt_pk_bf16_f32 v104, v80, v81
    v_cvt_pk_bf16_f32 v105, v82, v83
    v_cvt_pk_bf16_f32 v106, v84, v85
    v_cvt_pk_bf16_f32 v107, v86, v87
    v_cvt_pk_bf16_f32 v108, v88, v89
    v_cvt_pk_bf16_f32 v109, v90, v91
    v_cvt_pk_bf16_f32 v110, v92, v93
    v_cvt_pk_bf16_f32 v111, v94, v95
    v_lshlrev_b32 v64, 16, v96
    v_and_b32 v65, 0xffff0000, v96
    v_lshlrev_b32 v66, 16, v97
    v_and_b32 v67, 0xffff0000, v97
    v_lshlrev_b32 v68, 16, v98
    v_and_b32 v69, 0xffff0000, v98
    v_lshlrev_b32 v70, 16, v99
    v_and_b32 v71, 0xffff0000, v99
    v_lshlrev_b32 v72, 16, v100
    v_and_b32 v73, 0xffff0000, v100
    v_lshlrev_b32 v74, 16, v101
    v_and_b32 v75, 0xffff0000, v101
    v_lshlrev_b32 v76, 16, v102
    v_and_b32 v77, 0xffff0000, v102
    v_lshlrev_b32 v78, 16, v103
    v_and_b32 v79, 0xffff0000, v103
    v_lshlrev_b32 v80, 16, v104
    v_and_b32 v81, 0xffff0000, v104
    v_lshlrev_b32 v82, 16, v105
    v_and_b32 v83, 0xffff0000, v105
    v_lshlrev_b32 v84, 16, v106
    v_and_b32 v85, 0xffff0000, v106
    v_lshlrev_b32 v86, 16, v107
    v_and_b32 v87, 0xffff0000, v107
    v_lshlrev_b32 v88, 16, v108
    v_and_b32 v89, 0xffff0000, v108
    v_lshlrev_b32 v90, 16, v109
    v_and_b32 v91, 0xffff0000, v109
    v_lshlrev_b32 v92, 16, v110
    v_and_b32 v93, 0xffff0000, v110
    v_lshlrev_b32 v94, 16, v111
    v_and_b32 v95, 0xffff0000, v111
    v_cvt_pk_f16_f32 v40, v64, v80
    v_cvt_pk_f16_f32 v41, v65, v81
    ds_write2_b32 v3, v40, v41 offset0:0 offset1:4
    v_cvt_pk_f16_f32 v42, v66, v82
    v_cvt_pk_f16_f32 v43, v67, v83
    ds_write2_b32 v3, v42, v43 offset0:8 offset1:12
    v_cvt_pk_f16_f32 v44, v68, v84
    v_cvt_pk_f16_f32 v45, v69, v85
    ds_write2_b32 v3, v44, v45 offset0:16 offset1:20
    v_cvt_pk_f16_f32 v46, v70, v86
    v_cvt_pk_f16_f32 v47, v71, v87
    ds_write2_b32 v3, v46, v47 offset0:24 offset1:28
    v_cvt_pk_f16_f32 v48, v72, v88
    v_cvt_pk_f16_f32 v49, v73, v89
    ds_write2_b32 v4, v48, v49 offset0:0 offset1:4
    v_cvt_pk_f16_f32 v50, v74, v90
    v_cvt_pk_f16_f32 v51, v75, v91
    ds_write2_b32 v4, v50, v51 offset0:8 offset1:12
    v_cvt_pk_f16_f32 v52, v76, v92
    v_cvt_pk_f16_f32 v53, v77, v93
    ds_write2_b32 v4, v52, v53 offset0:16 offset1:20
    v_cvt_pk_f16_f32 v54, v78, v94
    v_cvt_pk_f16_f32 v55, v79, v95
    ds_write2_b32 v4, v54, v55 offset0:24 offset1:28
    s_waitcnt lgkmcnt(0)
    s_mov_b64 exec, 1
    ds_add_u32 v56, v57 offset:32
    s_mov_b64 exec, -1
    s_waitcnt vmcnt(0)
    v_dot2_f32_bf16 v60, v96, v24, 0
    v_dot2_f32_bf16 v61, v104, v24, 0
    v_dot2_f32_bf16 v60, v97, v25, v60
    v_dot2_f32_bf16 v61, v105, v25, v61
    v_dot2_f32_bf16 v60, v98, v26, v60
    v_dot2_f32_bf16 v61, v106, v26, v61
    v_dot2_f32_bf16 v60, v99, v27, v60
    v_dot2_f32_bf16 v61, v107, v27, v61
    v_dot2_f32_bf16 v60, v100, v28, v60
    v_dot2_f32_bf16 v61, v108, v28, v61
    v_dot2_f32_bf16 v60, v101, v29, v60
    v_dot2_f32_bf16 v61, v109, v29, v61
    v_dot2_f32_bf16 v60, v102, v30, v60
    v_dot2_f32_bf16 v61, v110, v30, v61
    v_dot2_f32_bf16 v60, v103, v31, v60
    v_dot2_f32_bf16 v61, v111, v31, v61
    s_nop 4
k2_lnp:
    ds_read_b32 v58, v56 offset:32
    s_waitcnt lgkmcnt(0)
    v_readfirstlane_b32 s14, v58
    s_cmp_ge_u32 s14, 4
    s_cbranch_scc1 k2_lnp_done
    s_sleep 1
    s_branch k2_lnp
k2_lnp_done:
    s_nop 0
    ds_read_b128 v[64:67], v5 offset:0
    ds_read_b128 v[68:71], v5 offset:4608
    ds_read_b128 v[72:75], v5 offset:9216
    ds_read_b128 v[76:79], v5 offset:13824
    s_waitcnt lgkmcnt(3)
    buffer_store_dwordx4 v[64:67], v6, s[52:55], s10 offen sc1
    s_add_u32 s10, s10, 0x100000
    s_waitcnt lgkmcnt(2)
    buffer_store_dwordx4 v[68:71], v6, s[52:55], s10 offen sc1
    s_add_u32 s10, s10, 0x100000
    s_waitcnt lgkmcnt(1)
    buffer_store_dwordx4 v[72:75], v6, s[52:55], s10 offen sc1
    s_add_u32 s10, s10, 0x100000
    s_waitcnt lgkmcnt(0)
    buffer_store_dwordx4 v[76:79], v6, s[52:55], s10 offen sc1
    s_waitcnt lgkmcnt(0)
    s_mov_b64 exec, 1
    ds_add_u32 v56, v57 offset:52
    s_mov_b64 exec, -1
    v_permlane32_swap_b32 v60, v61
    v_add_f32 v60, v60, v61
    v_mov_b32 v62, v60
    s_nop 1
    v_permlane16_swap_b32 v60, v62
    v_add_f32 v60, v60, v62
    s_nop 1
    v_add_f32 v60, v60, v60 row_ror:8
    s_nop 1
    v_add_f32 v60, v60, v60 row_ror:4
    s_nop 1
    v_add_f32 v60, v60, v60 row_ror:2
    s_nop 1
    v_add_f32 v60, v60, v60 row_ror:1
    v_cvt_pk_bf16_f32 v60, 0, v60
    v_ashrrev_i32 v61, 31, v60
    v_or_b32 v61, 0x80000000, v61
    v_xor_b32 v60, v60, v61
    v_and_b32 v60, 0xffff0000, v60
    v_lshrrev_b32 v62, 5, v1
    s_sub_u32 s14, 2047, s20
    v_sub_u32 v61, s14, v62
    v_or_b32 v60, v60, v61
    s_nop 0
    v_readlane_b32 s14, v60, 0
    v_readlane_b32 s15, v60, 32
    v_lshlrev_b32 v62, 3, v62
    s_lshl_b32 s9, s20, 3
    s_add_u32 s9, s9, 0x400000
    s_max_u32 s14, s14, s15
    s_lshl_b32 s10, s20, 1
    s_add_u32 s10, s10, 0x404000
    v_mov_b32 v60, s14
    s_mov_b32 exec_lo, 1
    s_mov_b32 exec_hi, 1
    buffer_store_dwordx2 v[38:39], v62, s[52:55], s9 offen sc1
    s_mov_b32 exec_hi, 0
    ds_max_u32 v56, v60 offset:56
    s_mov_b64 exec, -1
    v_mov_b32 v60, 143040
    v_mov_b32 v61, 1
    v_lshlrev_b32 v5, 4, v1
    v_mov_b32 v6, 0
    v_lshlrev_b32 v7, 3, v1
    v_lshlrev_b32 v8, 2, v1
    s_lshl_b32 s9, s6, 14
    s_lshl_b32 s10, s3, 12
    s_add_u32 s9, s9, s10
    s_add_u32 s21, s9, 0xa00000
    s_mov_b32 s11, 0x404000
    s_lshl_b32 s10, s8, 9
    v_and_b32 v62, 3, v1
    v_mul_u32_u24 v62, 13328, v62
    v_and_b32 v63, 60, v1
    v_lshl_add_u32 v62, v63, 2, v62
    s_lshl_b32 s13, s3, 10
    v_add_u32 v62, s13, v62
    buffer_load_dword v54, v6, s[76:79], 0 offen sc1
    s_waitcnt vmcnt(0)
    s_waitcnt lgkmcnt(0)
    s_mov_b64 exec, 1
    ds_add_u32 v60, v61 offset:36
    s_mov_b64 exec, -1
    s_cmp_lg_u32 s3, 0
    s_cbranch_scc1 k2_e_rest
k2_eack:
    ds_read_b32 v52, v60 offset:36
    s_waitcnt lgkmcnt(0)
    v_readfirstlane_b32 s14, v52
    s_cmp_ge_u32 s14, 8
    s_cbranch_scc1 k2_eack_done
    s_sleep 1
    s_branch k2_eack
k2_eack_done:
    s_nop 0
k2_ep:
    v_readfirstlane_b32 s26, v54
    s_cmp_lg_u32 s26, 0
    s_cbranch_scc1 k2_ep_done
    s_sleep 4
    buffer_load_dword v54, v6, s[76:79], 0 offen sc1
    s_waitcnt vmcnt(0)
    s_branch k2_ep
k2_ep_done:
    s_lshl_b32 s25, s2, 4
    s_add_u32 s25, s25, 0x5f8000
    ds_read_b32 v55, v60 offset:56
    s_waitcnt lgkmcnt(0)
    s_mov_b64 exec, 1
    buffer_store_dwordx2 v[54:55], v6, s[52:55], s25 offen sc1
    s_mov_b64 exec, -1
k2_sync:
    buffer_load_dwordx2 v[52:53], v6, s[52:55], s24 offen sc1
    s_waitcnt vmcnt(0)
    v_readfirstlane_b32 s14, v52
    s_cmp_eq_u32 s14, s26
    s_cbranch_scc1 k2_sync_done
    s_sleep 2
    s_branch k2_sync
k2_sync_done:
    s_nop 0
    s_waitcnt lgkmcnt(0)
    s_mov_b64 exec, 1
    ds_add_u32 v60, v61 offset:40
    s_mov_b64 exec, -1
    v_readfirstlane_b32 s14, v53
    s_and_b32 s15, s14, 0x7ff
    s_sub_u32 s15, 2047, s15
    s_lshl_b32 s13, s15, 11
    s_add_u32 s13, s13, s10
    s_lshl_b32 s9, s15, 3
    s_add_u32 s9, s9, 0x400000
    buffer_load_dwordx4 v[24:27], v5, s[52:55], s21 offen offset:0
    buffer_load_dwordx4 v[28:31], v5, s[52:55], s21 offen offset:1024
    buffer_load_dwordx4 v[32:35], v5, s[52:55], s21 offen offset:2048
    buffer_load_dwordx4 v[36:39], v5, s[52:55], s21 offen offset:3072
    buffer_load_dwordx2 v[40:41], v7, s[48:51], s13 offen
    buffer_load_dwordx2 v[42:43], v6, s[52:55], s9 offen
    s_waitcnt lgkmcnt(0)
    s_mov_b64 exec, 1
    ds_add_u32 v60, v61 offset:20
    s_mov_b64 exec, -1
    s_waitcnt vmcnt(2)
    ds_write_b128 v62, v[24:27] offset:512
    ds_write_b128 v62, v[28:31] offset:768
    ds_write_b128 v62, v[32:35] offset:1024
    ds_write_b128 v62, v[36:39] offset:1280
    s_waitcnt lgkmcnt(0)
    s_mov_b64 exec, 1
    ds_add_u32 v60, v61 offset:0
    s_mov_b64 exec, -1
    s_waitcnt vmcnt(0)
    v_lshlrev_b32 v44, 16, v40
    v_and_b32 v45, 0xffff0000, v40
    v_lshlrev_b32 v46, 16, v41
    v_and_b32 v47, 0xffff0000, v41
    v_sub_f32 v44, v44, v42
    v_sub_f32 v45, v45, v42
    v_sub_f32 v46, v46, v42
    v_sub_f32 v47, v47, v42
    v_cvt_pk_bf16_f32 v44, 0, v44
    v_cvt_pk_bf16_f32 v45, 0, v45
    v_cvt_pk_bf16_f32 v46, 0, v46
    v_cvt_pk_bf16_f32 v47, 0, v47
    v_mul_f32 v44, v43, v44
    v_mul_f32 v45, v43, v45
    v_mul_f32 v46, v43, v46
    v_mul_f32 v47, v43, v47
    v_cvt_pk_bf16_f32 v48, v44, v45
    v_cvt_pk_bf16_f32 v49, v46, v47
    v_add_u32 v50, 141952, v7
    ds_write_b64 v50, v[48:49]
    v_mov_b32 v51, s14
    ds_write_b32 v60, v51 offset:24
    s_waitcnt lgkmcnt(0)
    s_mov_b64 exec, 1
    ds_add_u32 v60, v61 offset:4
    s_mov_b64 exec, -1
    s_branch k2_e_fin
k2_e_rest:
k2_ego:
    ds_read_b32 v52, v60 offset:40
    s_waitcnt lgkmcnt(0)
    v_readfirstlane_b32 s14, v52
    s_cmp_ge_u32 s14, 1
    s_cbranch_scc1 k2_ego_done
    s_sleep 1
    s_branch k2_ego
k2_ego_done:
    s_nop 0
    buffer_load_dwordx4 v[24:27], v5, s[52:55], s21 offen offset:0
    buffer_load_dwordx4 v[28:31], v5, s[52:55], s21 offen offset:1024
    buffer_load_dwordx4 v[32:35], v5, s[52:55], s21 offen offset:2048
    buffer_load_dwordx4 v[36:39], v5, s[52:55], s21 offen offset:3072
    s_waitcnt lgkmcnt(0)
    s_mov_b64 exec, 1
    ds_add_u32 v60, v61 offset:20
    s_mov_b64 exec, -1
    s_waitcnt vmcnt(0)
    ds_write_b128 v62, v[24:27] offset:512
    ds_write_b128 v62, v[28:31] offset:768
    ds_write_b128 v62, v[32:35] offset:1024
    ds_write_b128 v62, v[36:39] offset:1280
    s_waitcnt lgkmcnt(0)
    s_mov_b64 exec, 1
    ds_add_u32 v60, v61 offset:0
    s_mov_b64 exec, -1
k2_e_fin:
    s_setprio 0
    v_and_b32 v6, 15, v1
    v_lshrrev_b32 v7, 4, v1
    v_lshlrev_b32 v8, 11, v6
    v_lshl_add_u32 v8, v7, 4, v8
    s_lshl_b32 s11, s5, 6
    s_lshl_b32 s12, s11, 11
    s_lshl_b32 s13, s4, 8
    s_lshl_b32 s15, s3, 6
    s_add_u32 s13, s13, s15
    s_add_u32 s12, s12, s13
    s_mov_b32 s16, s12
    buffer_load_dwordx4 v[16:19], v8, s[48:51], s16 offen nt
    s_add_u32 s16, s16, 0x8000
    buffer_load_dwordx4 v[20:23], v8, s[48:51], s16 offen nt
    s_add_u32 s16, s16, 0x8000
    buffer_load_dwordx4 v[24:27], v8, s[48:51], s16 offen nt
    s_add_u32 s16, s16, 0x8000
    buffer_load_dwordx4 v[28:31], v8, s[48:51], s16 offen nt
    v_lshlrev_b32 v9, 3, v6
    s_lshl_b32 s15, s11, 3
    s_add_u32 s15, s15, 0x400000
    buffer_load_dwordx2 v[32:33], v9, s[52:55], s15 offen offset:0
    buffer_load_dwordx2 v[34:35], v9, s[52:55], s15 offen offset:128
    buffer_load_dwordx2 v[36:37], v9, s[52:55], s15 offen offset:256
    buffer_load_dwordx2 v[38:39], v9, s[52:55], s15 offen offset:384
    v_lshlrev_b32 v9, 4, v7
    buffer_load_dwordx4 v[40:43], v9, s[56:59], s13 offen
    v_lshrrev_b32 v2, 3, v1
    v_and_b32 v3, 7, v1
    v_lshlrev_b32 v4, 12, v2
    v_lshl_add_u32 v4, v3, 4, v4
    v_and_b32 v5, 2, v2
    v_xor_b32 v3, v3, v5
    v_lshlrev_b32 v5, 7, v2
    v_lshl_add_u32 v5, v3, 4, v5
    s_lshl_b32 s15, s3, 12
    s_add_u32 s15, s15, 120960
    v_add_u32 v5, s15, v5
    v_xor_b32 v3, 64, v5
    s_lshl_b32 s17, s4, 7
    s_lshl_b32 s18, s3, 5
    s_add_u32 s17, s17, s18
    s_lshl_b32 s17, s17, 12
    s_lshl_b32 s18, s5, 7
    s_add_u32 s17, s17, s18
    s_lshl_b32 s18, s4, 12
    s_lshr_b32 s19, s5, 2
    s_lshl_b32 s19, s19, 9
    s_add_u32 s18, s18, s19
    s_lshl_b32 s19, s3, 7
    s_add_u32 s18, s18, s19
    s_add_u32 s18, s18, 0x5e0000
    v_and_b32 v2, 31, v1
    v_lshlrev_b32 v2, 2, v2
    v_bfe_u32 v10, v1, 2, 2
    v_and_b32 v11, 3, v1
    v_lshrrev_b32 v12, 1, v10
    v_and_b32 v13, 1, v7
    v_lshl_or_b32 v12, v13, 1, v12
    v_lshl_add_u32 v14, v7, 3, v10
    v_lshlrev_b32 v14, 7, v14
    v_lshl_add_u32 v14, v11, 3, v14
    v_add_u32 v14, s15, v14
    v_lshl_add_u32 v12, v12, 5, v14
    v_xor_b32 v13, 32, v12
    v_xor_b32 v14, 64, v12
    v_xor_b32 v15, 96, v12
    v_add_u32 v6, s11, v6
    s_nop 4
k2_ek:
    ds_read_b32 v52, v60 offset:4
    s_waitcnt lgkmcnt(0)
    v_readfirstlane_b32 s14, v52
    s_cmp_ge_u32 s14, 1
    s_cbranch_scc1 k2_ek_done
    s_sleep 1
    s_branch k2_ek
k2_ek_done:
    s_nop 0
    ds_read_b32 v52, v60 offset:24
    s_waitcnt lgkmcnt(0)
    v_readfirstlane_b32 s14, v52
    s_and_b32 s14, s14, 0x7ff
    s_sub_u32 s14, 2047, s14
    s_lshr_b32 s19, s5, 2
    s_add_u32 s19, s19, 4
    s_min_u32 s19, s19, 8
    s_lshl_b32 s19, s19, 2
k2_eg:
    ds_read_b32 v52, v60 offset:28
    s_waitcnt lgkmcnt(0)
    v_readfirstlane_b32 s20, v52
    s_cmp_ge_u32 s20, s19
    s_cbranch_scc1 k2_eg_done
    s_sleep 2
    s_branch k2_eg
k2_eg_done:
    s_nop 0
    s_waitcnt vmcnt(0)
    v_lshlrev_b32 v64, 16, v16
    v_and_b32 v65, 0xffff0000, v16
    v_lshlrev_b32 v66, 16, v17
    v_and_b32 v67, 0xffff0000, v17
    v_lshlrev_b32 v68, 16, v18
    v_and_b32 v69, 0xffff0000, v18
    v_lshlrev_b32 v70, 16, v19
    v_and_b32 v71, 0xffff0000, v19
    v_lshlrev_b32 v72, 16, v20
    v_and_b32 v73, 0xffff0000, v20
    v_lshlrev_b32 v74, 16, v21
    v_and_b32 v75, 0xffff0000, v21
    v_lshlrev_b32 v76, 16, v22
    v_and_b32 v77, 0xffff0000, v22
    v_lshlrev_b32 v78, 16, v23
    v_and_b32 v79, 0xffff0000, v23
    v_lshlrev_b32 v80, 16, v24
    v_and_b32 v81, 0xffff0000, v24
    v_lshlrev_b32 v82, 16, v25
    v_and_b32 v83, 0xffff0000, v25
    v_lshlrev_b32 v84, 16, v26
    v_and_b32 v85, 0xffff0000, v26
    v_lshlrev_b32 v86, 16, v27
    v_and_b32 v87, 0xffff0000, v27
    v_lshlrev_b32 v88, 16, v28
    v_and_b32 v89, 0xffff0000, v28
    v_lshlrev_b32 v90, 16, v29
    v_and_b32 v91, 0xffff0000, v29
    v_lshlrev_b32 v92, 16, v30
    v_and_b32 v93, 0xffff0000, v30
    v_lshlrev_b32 v94, 16, v31
    v_and_b32 v95, 0xffff0000, v31
    v_lshlrev_b32 v44, 16, v40
    v_and_b32 v45, 0xffff0000, v40
    v_lshlrev_b32 v46, 16, v41
    v_and_b32 v47, 0xffff0000, v41
    v_lshlrev_b32 v48, 16, v42
    v_and_b32 v49, 0xffff0000, v42
    v_lshlrev_b32 v50, 16, v43
    v_and_b32 v51, 0xffff0000, v43
    v_sub_f32 v96, v64, v32
    v_sub_f32 v97, v65, v32
    v_sub_f32 v98, v66, v32
    v_sub_f32 v99, v67, v32
    v_sub_f32 v100, v68, v32
    v_sub_f32 v101, v69, v32
    v_sub_f32 v102, v70, v32
    v_sub_f32 v103, v71, v32
    v_sub_f32 v104, v72, v34
    v_sub_f32 v105, v73, v34
    v_sub_f32 v106, v74, v34
    v_sub_f32 v107, v75, v34
    v_sub_f32 v108, v76, v34
    v_sub_f32 v109, v77, v34
    v_sub_f32 v110, v78, v34
    v_sub_f32 v111, v79, v34
    v_sub_f32 v112, v80, v36
    v_sub_f32 v113, v81, v36
    v_sub_f32 v114, v82, v36
    v_sub_f32 v115, v83, v36
    v_sub_f32 v116, v84, v36
    v_sub_f32 v117, v85, v36
    v_sub_f32 v118, v86, v36
    v_sub_f32 v119, v87, v36
    v_sub_f32 v120, v88, v38
    v_sub_f32 v121, v89, v38
    v_sub_f32 v122, v90, v38
    v_sub_f32 v123, v91, v38
    v_sub_f32 v124, v92, v38
    v_sub_f32 v125, v93, v38
    v_sub_f32 v126, v94, v38
    v_sub_f32 v127, v95, v38
    v_cvt_pk_bf16_f32 v96, 0, v96
    v_cvt_pk_bf16_f32 v97, 0, v97
    v_cvt_pk_bf16_f32 v98, 0, v98
    v_cvt_pk_bf16_f32 v99, 0, v99
    v_cvt_pk_bf16_f32 v100, 0, v100
    v_cvt_pk_bf16_f32 v101, 0, v101
    v_cvt_pk_bf16_f32 v102, 0, v102
    v_cvt_pk_bf16_f32 v103, 0, v103
    v_cvt_pk_bf16_f32 v104, 0, v104
    v_cvt_pk_bf16_f32 v105, 0, v105
    v_cvt_pk_bf16_f32 v106, 0, v106
    v_cvt_pk_bf16_f32 v107, 0, v107
    v_cvt_pk_bf16_f32 v108, 0, v108
    v_cvt_pk_bf16_f32 v109, 0, v109
    v_cvt_pk_bf16_f32 v110, 0, v110
    v_cvt_pk_bf16_f32 v111, 0, v111
    v_cvt_pk_bf16_f32 v112, 0, v112
    v_cvt_pk_bf16_f32 v113, 0, v113
    v_cvt_pk_bf16_f32 v114, 0, v114
    v_cvt_pk_bf16_f32 v115, 0, v115
    v_cvt_pk_bf16_f32 v116, 0, v116
    v_cvt_pk_bf16_f32 v117, 0, v117
    v_cvt_pk_bf16_f32 v118, 0, v118
    v_cvt_pk_bf16_f32 v119, 0, v119
    v_cvt_pk_bf16_f32 v120, 0, v120
    v_cvt_pk_bf16_f32 v121, 0, v121
    v_cvt_pk_bf16_f32 v122, 0, v122
    v_cvt_pk_bf16_f32 v123, 0, v123
    v_cvt_pk_bf16_f32 v124, 0, v124
    v_cvt_pk_bf16_f32 v125, 0, v125
    v_cvt_pk_bf16_f32 v126, 0, v126
    v_cvt_pk_bf16_f32 v127, 0, v127
    v_mul_f32 v96, v96, v33
    v_mul_f32 v97, v97, v33
    v_mul_f32 v98, v98, v33
    v_mul_f32 v99, v99, v33
    v_mul_f32 v100, v100, v33
    v_mul_f32 v101, v101, v33
    v_mul_f32 v102, v102, v33
    v_mul_f32 v103, v103, v33
    v_mul_f32 v104, v104, v35
    v_mul_f32 v105, v105, v35
    v_mul_f32 v106, v106, v35
    v_mul_f32 v107, v107, v35
    v_mul_f32 v108, v108, v35
    v_mul_f32 v109, v109, v35
    v_mul_f32 v110, v110, v35
    v_mul_f32 v111, v111, v35
    v_mul_f32 v112, v112, v37
    v_mul_f32 v113, v113, v37
    v_mul_f32 v114, v114, v37
    v_mul_f32 v115, v115, v37
    v_mul_f32 v116, v116, v37
    v_mul_f32 v117, v117, v37
    v_mul_f32 v118, v118, v37
    v_mul_f32 v119, v119, v37
    v_mul_f32 v120, v120, v39
    v_mul_f32 v121, v121, v39
    v_mul_f32 v122, v122, v39
    v_mul_f32 v123, v123, v39
    v_mul_f32 v124, v124, v39
    v_mul_f32 v125, v125, v39
    v_mul_f32 v126, v126, v39
    v_mul_f32 v127, v127, v39
    v_cvt_pk_bf16_f32 v96, 0, v96
    v_cvt_pk_bf16_f32 v97, 0, v97
    v_cvt_pk_bf16_f32 v98, 0, v98
    v_cvt_pk_bf16_f32 v99, 0, v99
    v_cvt_pk_bf16_f32 v100, 0, v100
    v_cvt_pk_bf16_f32 v101, 0, v101
    v_cvt_pk_bf16_f32 v102, 0, v102
    v_cvt_pk_bf16_f32 v103, 0, v103
    v_cvt_pk_bf16_f32 v104, 0, v104
    v_cvt_pk_bf16_f32 v105, 0, v105
    v_cvt_pk_bf16_f32 v106, 0, v106
    v_cvt_pk_bf16_f32 v107, 0, v107
    v_cvt_pk_bf16_f32 v108, 0, v108
    v_cvt_pk_bf16_f32 v109, 0, v109
    v_cvt_pk_bf16_f32 v110, 0, v110
    v_cvt_pk_bf16_f32 v111, 0, v111
    v_cvt_pk_bf16_f32 v112, 0, v112
    v_cvt_pk_bf16_f32 v113, 0, v113
    v_cvt_pk_bf16_f32 v114, 0, v114
    v_cvt_pk_bf16_f32 v115, 0, v115
    v_cvt_pk_bf16_f32 v116, 0, v116
    v_cvt_pk_bf16_f32 v117, 0, v117
    v_cvt_pk_bf16_f32 v118, 0, v118
    v_cvt_pk_bf16_f32 v119, 0, v119
    v_cvt_pk_bf16_f32 v120, 0, v120
    v_cvt_pk_bf16_f32 v121, 0, v121
    v_cvt_pk_bf16_f32 v122, 0, v122
    v_cvt_pk_bf16_f32 v123, 0, v123
    v_cvt_pk_bf16_f32 v124, 0, v124
    v_cvt_pk_bf16_f32 v125, 0, v125
    v_cvt_pk_bf16_f32 v126, 0, v126
    v_cvt_pk_bf16_f32 v127, 0, v127
    v_mul_f32 v128, v96, v44
    v_mul_f32 v129, v97, v45
    v_mul_f32 v130, v98, v46
    v_mul_f32 v131, v99, v47
    v_mul_f32 v132, v100, v48
    v_mul_f32 v133, v101, v49
    v_mul_f32 v134, v102, v50
    v_mul_f32 v135, v103, v51
    v_mul_f32 v136, v104, v44
    v_mul_f32 v137, v105, v45
    v_mul_f32 v138, v106, v46
    v_mul_f32 v139, v107, v47
    v_mul_f32 v140, v108, v48
    v_mul_f32 v141, v109, v49
    v_mul_f32 v142, v110, v50
    v_mul_f32 v143, v111, v51
    v_mul_f32 v144, v112, v44
    v_mul_f32 v145, v113, v45
    v_mul_f32 v146, v114, v46
    v_mul_f32 v147, v115, v47
    v_mul_f32 v148, v116, v48
    v_mul_f32 v149, v117, v49
    v_mul_f32 v150, v118, v50
    v_mul_f32 v151, v119, v51
    v_mul_f32 v152, v120, v44
    v_mul_f32 v153, v121, v45
    v_mul_f32 v154, v122, v46
    v_mul_f32 v155, v123, v47
    v_mul_f32 v156, v124, v48
    v_mul_f32 v157, v125, v49
    v_mul_f32 v158, v126, v50
    v_mul_f32 v159, v127, v51
    v_cvt_pk_bf16_f32 v128, 0, v128
    v_cvt_pk_bf16_f32 v129, 0, v129
    v_cvt_pk_bf16_f32 v130, 0, v130
    v_cvt_pk_bf16_f32 v131, 0, v131
    v_cvt_pk_bf16_f32 v132, 0, v132
    v_cvt_pk_bf16_f32 v133, 0, v133
    v_cvt_pk_bf16_f32 v134, 0, v134
    v_cvt_pk_bf16_f32 v135, 0, v135
    v_cvt_pk_bf16_f32 v136, 0, v136
    v_cvt_pk_bf16_f32 v137, 0, v137
    v_cvt_pk_bf16_f32 v138, 0, v138
    v_cvt_pk_bf16_f32 v139, 0, v139
    v_cvt_pk_bf16_f32 v140, 0, v140
    v_cvt_pk_bf16_f32 v141, 0, v141
    v_cvt_pk_bf16_f32 v142, 0, v142
    v_cvt_pk_bf16_f32 v143, 0, v143
    v_cvt_pk_bf16_f32 v144, 0, v144
    v_cvt_pk_bf16_f32 v145, 0, v145
    v_cvt_pk_bf16_f32 v146, 0, v146
    v_cvt_pk_bf16_f32 v147, 0, v147
    v_cvt_pk_bf16_f32 v148, 0, v148
    v_cvt_pk_bf16_f32 v149, 0, v149
    v_cvt_pk_bf16_f32 v150, 0, v150
    v_cvt_pk_bf16_f32 v151, 0, v151
    v_cvt_pk_bf16_f32 v152, 0, v152
    v_cvt_pk_bf16_f32 v153, 0, v153
    v_cvt_pk_bf16_f32 v154, 0, v154
    v_cvt_pk_bf16_f32 v155, 0, v155
    v_cvt_pk_bf16_f32 v156, 0, v156
    v_cvt_pk_bf16_f32 v157, 0, v157
    v_cvt_pk_bf16_f32 v158, 0, v158
    v_cvt_pk_bf16_f32 v159, 0, v159
    s_nop 4
k2_eyp:
    s_mov_b32 s18, s17
    buffer_load_dwordx4 v[16:19], v4, s[52:55], s18 offen sc1
    s_add_u32 s18, s18, 0x8000
    buffer_load_dwordx4 v[20:23], v4, s[52:55], s18 offen sc1
    s_add_u32 s18, s18, 0x8000
    buffer_load_dwordx4 v[24:27], v4, s[52:55], s18 offen sc1
    s_add_u32 s18, s18, 0x8000
    buffer_load_dwordx4 v[28:31], v4, s[52:55], s18 offen sc1
    s_waitcnt vmcnt(0)
    v_max3_u32 v52, v16, v17, v18
    v_max3_u32 v52, v52, v19, v20
    v_max3_u32 v52, v52, v21, v22
    v_max3_u32 v52, v52, v23, v24
    v_max3_u32 v52, v52, v25, v26
    v_max3_u32 v52, v52, v27, v28
    v_max3_u32 v52, v52, v29, v30
    v_max_u32 v52, v52, v31
    v_cmp_ne_u32 vcc, -1, v52
    s_cmp_eq_u64 vcc, -1
    s_cbranch_scc1 k2_eyp_done
    s_sleep 4
    s_branch k2_eyp
k2_eyp_done:
    s_nop 0
    ds_write_b128 v5, v[16:19] offset:0
    ds_write_b128 v3, v[20:23] offset:1024
    ds_write_b128 v5, v[24:27] offset:2048
    ds_write_b128 v3, v[28:31] offset:3072
    ds_read_b64_tr_b16 v[32:33], v12
    ds_read_b64_tr_b16 v[34:35], v12 offset:512
    ds_read_b64_tr_b16 v[36:37], v13
    ds_read_b64_tr_b16 v[38:39], v13 offset:512
    ds_read_b64_tr_b16 v[40:41], v14
    ds_read_b64_tr_b16 v[42:43], v14 offset:512
    ds_read_b64_tr_b16 v[44:45], v15
    ds_read_b64_tr_b16 v[46:47], v15 offset:512
    s_waitcnt lgkmcnt(6)
    v_lshlrev_b32 v48, 16, v32
    v_and_b32 v49, 0xffff0000, v32
    v_lshlrev_b32 v50, 16, v33
    v_and_b32 v51, 0xffff0000, v33
    v_lshlrev_b32 v52, 16, v34
    v_and_b32 v53, 0xffff0000, v34
    v_lshlrev_b32 v54, 16, v35
    v_and_b32 v55, 0xffff0000, v35
    v_add_f32 v48, v48, v128
    v_add_f32 v49, v49, v129
    v_add_f32 v50, v50, v130
    v_add_f32 v51, v51, v131
    v_add_f32 v52, v52, v132
    v_add_f32 v53, v53, v133
    v_add_f32 v54, v54, v134
    v_add_f32 v55, v55, v135
    v_cvt_pk_bf16_f32 v48, 0, v48
    v_cvt_pk_bf16_f32 v49, 0, v49
    v_cvt_pk_bf16_f32 v50, 0, v50
    v_cvt_pk_bf16_f32 v51, 0, v51
    v_cvt_pk_bf16_f32 v52, 0, v52
    v_cvt_pk_bf16_f32 v53, 0, v53
    v_cvt_pk_bf16_f32 v54, 0, v54
    v_cvt_pk_bf16_f32 v55, 0, v55
    v_add_f32 v48, v48, v64
    v_add_f32 v49, v49, v65
    v_add_f32 v50, v50, v66
    v_add_f32 v51, v51, v67
    v_add_f32 v52, v52, v68
    v_add_f32 v53, v53, v69
    v_add_f32 v54, v54, v70
    v_add_f32 v55, v55, v71
    v_cvt_pk_bf16_f32 v48, 0, v48
    v_cvt_pk_bf16_f32 v49, 0, v49
    v_cvt_pk_bf16_f32 v50, 0, v50
    v_cvt_pk_bf16_f32 v51, 0, v51
    v_cvt_pk_bf16_f32 v52, 0, v52
    v_cvt_pk_bf16_f32 v53, 0, v53
    v_cvt_pk_bf16_f32 v54, 0, v54
    v_cvt_pk_bf16_f32 v55, 0, v55
    v_add_f32 v48, v48, v96
    v_add_f32 v49, v49, v97
    v_add_f32 v50, v50, v98
    v_add_f32 v51, v51, v99
    v_add_f32 v52, v52, v100
    v_add_f32 v53, v53, v101
    v_add_f32 v54, v54, v102
    v_add_f32 v55, v55, v103
    v_cvt_pk_bf16_f32 v16, v48, v49
    v_cvt_pk_bf16_f32 v17, v50, v51
    v_cvt_pk_bf16_f32 v18, v52, v53
    v_cvt_pk_bf16_f32 v19, v54, v55
    v_cmp_ne_u32 vcc, s14, v6
    s_mov_b64 exec, vcc
    buffer_store_dwordx4 v[16:19], v8, s[72:75], s12 offen nt
    s_mov_b64 exec, -1
    s_add_u32 s12, s12, 0x8000
    s_sub_u32 s14, s14, 16
    s_waitcnt lgkmcnt(4)
    v_lshlrev_b32 v48, 16, v36
    v_and_b32 v49, 0xffff0000, v36
    v_lshlrev_b32 v50, 16, v37
    v_and_b32 v51, 0xffff0000, v37
    v_lshlrev_b32 v52, 16, v38
    v_and_b32 v53, 0xffff0000, v38
    v_lshlrev_b32 v54, 16, v39
    v_and_b32 v55, 0xffff0000, v39
    v_add_f32 v48, v48, v136
    v_add_f32 v49, v49, v137
    v_add_f32 v50, v50, v138
    v_add_f32 v51, v51, v139
    v_add_f32 v52, v52, v140
    v_add_f32 v53, v53, v141
    v_add_f32 v54, v54, v142
    v_add_f32 v55, v55, v143
    v_cvt_pk_bf16_f32 v48, 0, v48
    v_cvt_pk_bf16_f32 v49, 0, v49
    v_cvt_pk_bf16_f32 v50, 0, v50
    v_cvt_pk_bf16_f32 v51, 0, v51
    v_cvt_pk_bf16_f32 v52, 0, v52
    v_cvt_pk_bf16_f32 v53, 0, v53
    v_cvt_pk_bf16_f32 v54, 0, v54
    v_cvt_pk_bf16_f32 v55, 0, v55
    v_add_f32 v48, v48, v72
    v_add_f32 v49, v49, v73
    v_add_f32 v50, v50, v74
    v_add_f32 v51, v51, v75
    v_add_f32 v52, v52, v76
    v_add_f32 v53, v53, v77
    v_add_f32 v54, v54, v78
    v_add_f32 v55, v55, v79
    v_cvt_pk_bf16_f32 v48, 0, v48
    v_cvt_pk_bf16_f32 v49, 0, v49
    v_cvt_pk_bf16_f32 v50, 0, v50
    v_cvt_pk_bf16_f32 v51, 0, v51
    v_cvt_pk_bf16_f32 v52, 0, v52
    v_cvt_pk_bf16_f32 v53, 0, v53
    v_cvt_pk_bf16_f32 v54, 0, v54
    v_cvt_pk_bf16_f32 v55, 0, v55
    v_add_f32 v48, v48, v104
    v_add_f32 v49, v49, v105
    v_add_f32 v50, v50, v106
    v_add_f32 v51, v51, v107
    v_add_f32 v52, v52, v108
    v_add_f32 v53, v53, v109
    v_add_f32 v54, v54, v110
    v_add_f32 v55, v55, v111
    v_cvt_pk_bf16_f32 v20, v48, v49
    v_cvt_pk_bf16_f32 v21, v50, v51
    v_cvt_pk_bf16_f32 v22, v52, v53
    v_cvt_pk_bf16_f32 v23, v54, v55
    v_cmp_ne_u32 vcc, s14, v6
    s_mov_b64 exec, vcc
    buffer_store_dwordx4 v[20:23], v8, s[72:75], s12 offen nt
    s_mov_b64 exec, -1
    s_add_u32 s12, s12, 0x8000
    s_sub_u32 s14, s14, 16
    s_waitcnt lgkmcnt(2)
    v_lshlrev_b32 v48, 16, v40
    v_and_b32 v49, 0xffff0000, v40
    v_lshlrev_b32 v50, 16, v41
    v_and_b32 v51, 0xffff0000, v41
    v_lshlrev_b32 v52, 16, v42
    v_and_b32 v53, 0xffff0000, v42
    v_lshlrev_b32 v54, 16, v43
    v_and_b32 v55, 0xffff0000, v43
    v_add_f32 v48, v48, v144
    v_add_f32 v49, v49, v145
    v_add_f32 v50, v50, v146
    v_add_f32 v51, v51, v147
    v_add_f32 v52, v52, v148
    v_add_f32 v53, v53, v149
    v_add_f32 v54, v54, v150
    v_add_f32 v55, v55, v151
    v_cvt_pk_bf16_f32 v48, 0, v48
    v_cvt_pk_bf16_f32 v49, 0, v49
    v_cvt_pk_bf16_f32 v50, 0, v50
    v_cvt_pk_bf16_f32 v51, 0, v51
    v_cvt_pk_bf16_f32 v52, 0, v52
    v_cvt_pk_bf16_f32 v53, 0, v53
    v_cvt_pk_bf16_f32 v54, 0, v54
    v_cvt_pk_bf16_f32 v55, 0, v55
    v_add_f32 v48, v48, v80
    v_add_f32 v49, v49, v81
    v_add_f32 v50, v50, v82
    v_add_f32 v51, v51, v83
    v_add_f32 v52, v52, v84
    v_add_f32 v53, v53, v85
    v_add_f32 v54, v54, v86
    v_add_f32 v55, v55, v87
    v_cvt_pk_bf16_f32 v48, 0, v48
    v_cvt_pk_bf16_f32 v49, 0, v49
    v_cvt_pk_bf16_f32 v50, 0, v50
    v_cvt_pk_bf16_f32 v51, 0, v51
    v_cvt_pk_bf16_f32 v52, 0, v52
    v_cvt_pk_bf16_f32 v53, 0, v53
    v_cvt_pk_bf16_f32 v54, 0, v54
    v_cvt_pk_bf16_f32 v55, 0, v55
    v_add_f32 v48, v48, v112
    v_add_f32 v49, v49, v113
    v_add_f32 v50, v50, v114
    v_add_f32 v51, v51, v115
    v_add_f32 v52, v52, v116
    v_add_f32 v53, v53, v117
    v_add_f32 v54, v54, v118
    v_add_f32 v55, v55, v119
    v_cvt_pk_bf16_f32 v24, v48, v49
    v_cvt_pk_bf16_f32 v25, v50, v51
    v_cvt_pk_bf16_f32 v26, v52, v53
    v_cvt_pk_bf16_f32 v27, v54, v55
    v_cmp_ne_u32 vcc, s14, v6
    s_mov_b64 exec, vcc
    buffer_store_dwordx4 v[24:27], v8, s[72:75], s12 offen nt
    s_mov_b64 exec, -1
    s_add_u32 s12, s12, 0x8000
    s_sub_u32 s14, s14, 16
    s_waitcnt lgkmcnt(0)
    v_lshlrev_b32 v48, 16, v44
    v_and_b32 v49, 0xffff0000, v44
    v_lshlrev_b32 v50, 16, v45
    v_and_b32 v51, 0xffff0000, v45
    v_lshlrev_b32 v52, 16, v46
    v_and_b32 v53, 0xffff0000, v46
    v_lshlrev_b32 v54, 16, v47
    v_and_b32 v55, 0xffff0000, v47
    v_add_f32 v48, v48, v152
    v_add_f32 v49, v49, v153
    v_add_f32 v50, v50, v154
    v_add_f32 v51, v51, v155
    v_add_f32 v52, v52, v156
    v_add_f32 v53, v53, v157
    v_add_f32 v54, v54, v158
    v_add_f32 v55, v55, v159
    v_cvt_pk_bf16_f32 v48, 0, v48
    v_cvt_pk_bf16_f32 v49, 0, v49
    v_cvt_pk_bf16_f32 v50, 0, v50
    v_cvt_pk_bf16_f32 v51, 0, v51
    v_cvt_pk_bf16_f32 v52, 0, v52
    v_cvt_pk_bf16_f32 v53, 0, v53
    v_cvt_pk_bf16_f32 v54, 0, v54
    v_cvt_pk_bf16_f32 v55, 0, v55
    v_add_f32 v48, v48, v88
    v_add_f32 v49, v49, v89
    v_add_f32 v50, v50, v90
    v_add_f32 v51, v51, v91
    v_add_f32 v52, v52, v92
    v_add_f32 v53, v53, v93
    v_add_f32 v54, v54, v94
    v_add_f32 v55, v55, v95
    v_cvt_pk_bf16_f32 v48, 0, v48
    v_cvt_pk_bf16_f32 v49, 0, v49
    v_cvt_pk_bf16_f32 v50, 0, v50
    v_cvt_pk_bf16_f32 v51, 0, v51
    v_cvt_pk_bf16_f32 v52, 0, v52
    v_cvt_pk_bf16_f32 v53, 0, v53
    v_cvt_pk_bf16_f32 v54, 0, v54
    v_cvt_pk_bf16_f32 v55, 0, v55
    v_add_f32 v48, v48, v120
    v_add_f32 v49, v49, v121
    v_add_f32 v50, v50, v122
    v_add_f32 v51, v51, v123
    v_add_f32 v52, v52, v124
    v_add_f32 v53, v53, v125
    v_add_f32 v54, v54, v126
    v_add_f32 v55, v55, v127
    v_cvt_pk_bf16_f32 v28, v48, v49
    v_cvt_pk_bf16_f32 v29, v50, v51
    v_cvt_pk_bf16_f32 v30, v52, v53
    v_cvt_pk_bf16_f32 v31, v54, v55
    v_cmp_ne_u32 vcc, s14, v6
    s_mov_b64 exec, vcc
    buffer_store_dwordx4 v[28:31], v8, s[72:75], s12 offen nt
    s_mov_b64 exec, -1
k2_end:
    s_endpgm
.section .rodata,"a"
.p2align 6
.amdhsa_kernel parallel_sum__ssm_conv_s4d__moe_arch_mod__prompt_kernel
  .amdhsa_next_free_vgpr 168
  .amdhsa_next_free_sgpr 102
  .amdhsa_accum_offset 168
  .amdhsa_group_segment_fixed_size 0
  .amdhsa_kernarg_size 120
  .amdhsa_user_sgpr_count 2
  .amdhsa_user_sgpr_kernarg_segment_ptr 1
  .amdhsa_system_sgpr_workgroup_id_x 1
  .amdhsa_float_denorm_mode_32 3
.end_amdhsa_kernel
```
